```python
import torch

def _softmax(x, axis=-1):
    return torch.softmax(x, dim=axis)
def _gelu(x):
    return torch.nn.functional.gelu(x, approximate="tanh")
def _silu(x):
    return torch.nn.functional.silu(x)
def _sigmoid(x):
    return torch.sigmoid(x)
def _layernorm(x, axis=-1, eps=1e-5):
    m = x.mean(dim=axis, keepdim=True)
    v = x.var(dim=axis, keepdim=True, unbiased=False)
    return (x - m) / torch.sqrt(v + eps)
def _scatter_add(tgt, idx, src, axis=0):
    return tgt.clone().index_add_(axis, idx, src)
def _segment_sum(src, seg, n):
    out = torch.zeros((n,) + src.shape[1:], dtype=src.dtype)
    return out.index_add_(0, seg, src)
def _pad(x, pw):
    flat = tuple(v for pair in reversed(pw) for v in pair)
    return torch.nn.functional.pad(x, flat)

kernel_name = 'sequential_preLN__grouped_kv_mqa__dense_activation_gelu__prompt'

def setup_inputs():

    _w = (lambda a: (lambda t: t.to(torch.bfloat16) if t.is_floating_point() else t)(torch.as_tensor(a)))
    def _A_setup():
        B, S, D, H = 1, 2048, 448, 16
        Dh = D // H
        return {
            "x": _w((lambda *s: torch.randn(*s, dtype=torch.bfloat16) * 0.05)(B, S, D)),
            "wq": _w((lambda *s: torch.randn(*s, dtype=torch.bfloat16) * 0.05)(D, H * Dh)),
            "wk": _w((lambda *s: torch.randn(*s, dtype=torch.bfloat16) * 0.05)(D, Dh)),
            "wv": _w((lambda *s: torch.randn(*s, dtype=torch.bfloat16) * 0.05)(D, Dh)),
            "wo": _w((lambda *s: torch.randn(*s, dtype=torch.bfloat16) * 0.05)(H * Dh, D)),
        }
    _A_in = _A_setup()

    def _B_setup():
        B, S, D, F = 1, 2048, 448, 1792
        return {
            "x": _w((lambda *s: torch.randn(*s, dtype=torch.bfloat16) * 0.05)(B, S, D)),
            "w1": _w((lambda *s: torch.randn(*s, dtype=torch.bfloat16) * 0.8)(D, F) * (D ** -0.5)),
            "b1": _w((lambda *s: torch.randn(*s, dtype=torch.bfloat16) * 12.8)(F) * 0.01),
            "w2": _w((lambda *s: torch.randn(*s, dtype=torch.bfloat16) * 0.4)(F, D) * (F ** -0.5)),
            "b2": _w((lambda *s: torch.randn(*s, dtype=torch.bfloat16) * 6.4)(D) * 0.01),
        }
    _B_in = _B_setup()

    return {
        "A_x": _A_in["x"],
        "A_wq": _A_in["wq"],
        "A_wk": _A_in["wk"],
        "A_wv": _A_in["wv"],
        "A_wo": _A_in["wo"],
        "B_x": _B_in["x"],
        "B_w1": _B_in["w1"],
        "B_b1": _B_in["b1"],
        "B_w2": _B_in["w2"],
        "B_b2": _B_in["b2"],
    }

def reference(A_x, A_wq, A_wk, A_wv, A_wo, B_x, B_w1, B_b1, B_w2, B_b2):
    def _A_ref(x, wq, wk, wv, wo):
        B, S, D = x.shape
        H = 16
        Dh = D // H
        q = (lambda x, *d: x.permute(*d))((x @ wq).reshape(B, S, H, Dh), 0, 2, 1, 3)
        k = x @ wk
        v = x @ wv
        scores = torch.einsum("bhqd,bkd->bhqk", q, k) * (Dh ** -0.5)
        p = _softmax(scores, axis=-1)
        o = torch.einsum("bhqk,bkd->bhqd", p, v)
        return (lambda x, *d: x.permute(*d))(o, 0, 2, 1, 3).reshape(B, S, H * Dh) @ wo

    def _B_ref(x, w1, b1, w2, b2):
        h = torch.einsum("bsd,df->bsf", x, w1) + b1
        h = _gelu(h)
        return torch.einsum("bsf,fd->bsd", h, w2) + b2

    x = A_x
    h = x + _A_ref(_layernorm(x, axis=-1), A_wq, A_wk, A_wv, A_wo)
    h2 = h + _B_ref(_layernorm(h, axis=-1), B_w1, B_b1, B_w2, B_b2)
    return h2
```

```asm
; @launch grid=(256,1,1) block=(256,1,1) lds=163840
.amdgcn_target "amdgcn-amd-amdhsa--gfx950"
.text
.globl sequential_preLN__grouped_kv_mqa__dense_activation_gelu__prompt_kernel
.p2align 12
.p2align 8
.type sequential_preLN__grouped_kv_mqa__dense_activation_gelu__prompt_kernel,@function
sequential_preLN__grouped_kv_mqa__dense_activation_gelu__prompt_kernel:
    s_cmp_ge_u32 s2, 256
    s_cbranch_scc1 L_end
    s_load_dwordx16 s[4:19], s[0:1], 0
    s_load_dwordx8 s[20:27], s[0:1], 64
    s_load_dwordx2 s[28:29], s[0:1], 96
    s_memrealtime s[60:61]
    s_getpc_b64 s[58:59]
L_pc:
    s_lshr_b32 s49, s2, 3
    v_and_b32 v2, 15, v0
    s_mul_i32 s52, s49, 12
    v_add_u32 v5, s52, v2
    v_lshlrev_b32 v5, 7, v5
    v_min_u32 v5, L_codeend-L_pc-4, v5
    global_load_dword v15, v5, s[58:59]
    v_lshrrev_b32 v6, 6, v0
    v_and_b32 v1, 63, v0
    v_readfirstlane_b32 s30, v6
    v_bfe_u32 v3, v0, 4, 2
    v_lshlrev_b32 v4, 4, v1
    s_and_b32 s48, s2, 7
    s_lshl_b32 s50, s48, 5
    s_add_u32 s50, s50, s49
    s_and_b32 s94, s49, 1
    s_lshr_b32 s95, s50, 1
    s_lshr_b32 s51, s49, 1
    s_cmp_ge_u32 s51, 7
    s_cselect_b32 s52, 7, 0
    s_sub_u32 s51, s51, s52
    s_cmp_ge_u32 s51, 7
    s_cselect_b32 s52, 7, 0
    s_sub_u32 s51, s51, s52
    s_mov_b32 s101, 1056964608
    s_lshl_b32 s52, s95, 2
    s_add_u32 s52, s52, s30
    s_mul_i32 s52, s52, 3584
    v_mul_u32_u24 v7, 896, v3
    v_lshl_add_u32 v7, v2, 4, v7
    v_add_u32 v16, s52, v7
    v_mov_b32 v8, s101
    v_cmp_gt_u32 s[62:63], 8, v2
    s_mul_i32 s68, s30, 6272
    s_add_u32 s69, s68, 114688
    v_cndmask_b32 v17, v8, v16, s[62:63]
    s_lshl_b32 s70, s51, 10
    s_mul_i32 s64, s30, 7168
    s_mul_i32 s65, s51, 57344
    v_or_b32 v6, s2, v0
    v_cmp_eq_u32 vcc, 0, v6
    s_nop 1
    v_cndmask_b32 v18, v8, 0, vcc
    s_mul_i32 s55, s30, 448
    v_add_u32 v8, s55, v1
    s_mul_i32 s56, s94, 448
    v_add_u32 v5, 0, v8
    v_mul_u32_u24 v6, 2341, v5
    v_lshrrev_b32 v6, 16, v6
    v_mul_u32_u24 v7, 448, v6
    v_lshl_add_u32 v5, v5, 4, v7
    v_and_b32 v6, 8, v6
    v_lshlrev_b32 v6, 2, v6
    v_xor_b32 v5, v5, v6
    s_sub_u32 s57, s56, 0
    v_add_u32 v25, s57, v5
    v_add_u32 v5, 64, v8
    v_mul_u32_u24 v6, 2341, v5
    v_lshrrev_b32 v6, 16, v6
    v_mul_u32_u24 v7, 448, v6
    v_lshl_add_u32 v5, v5, 4, v7
    v_and_b32 v6, 8, v6
    v_lshlrev_b32 v6, 2, v6
    v_xor_b32 v5, v5, v6
    s_sub_u32 s57, s56, 1024
    v_add_u32 v26, s57, v5
    v_add_u32 v5, 128, v8
    v_mul_u32_u24 v6, 2341, v5
    v_lshrrev_b32 v6, 16, v6
    v_mul_u32_u24 v7, 448, v6
    v_lshl_add_u32 v5, v5, 4, v7
    v_and_b32 v6, 8, v6
    v_lshlrev_b32 v6, 2, v6
    v_xor_b32 v5, v5, v6
    s_sub_u32 s57, s56, 2048
    v_add_u32 v27, s57, v5
    v_add_u32 v5, 192, v8
    v_mul_u32_u24 v6, 2341, v5
    v_lshrrev_b32 v6, 16, v6
    v_mul_u32_u24 v7, 448, v6
    v_lshl_add_u32 v5, v5, 4, v7
    v_and_b32 v6, 8, v6
    v_lshlrev_b32 v6, 2, v6
    v_xor_b32 v5, v5, v6
    s_sub_u32 s57, s56, 3072
    v_add_u32 v28, s57, v5
    v_add_u32 v5, 256, v8
    v_mul_u32_u24 v6, 2341, v5
    v_lshrrev_b32 v6, 16, v6
    v_mul_u32_u24 v7, 448, v6
    v_lshl_add_u32 v5, v5, 4, v7
    v_and_b32 v6, 8, v6
    v_lshlrev_b32 v6, 2, v6
    v_xor_b32 v5, v5, v6
    s_sub_u32 s57, s56, 0
    v_add_u32 v29, s57, v5
    v_add_u32 v5, 320, v8
    v_mul_u32_u24 v6, 2341, v5
    v_lshrrev_b32 v6, 16, v6
    v_mul_u32_u24 v7, 448, v6
    v_lshl_add_u32 v5, v5, 4, v7
    v_and_b32 v6, 8, v6
    v_lshlrev_b32 v6, 2, v6
    v_xor_b32 v5, v5, v6
    s_sub_u32 s57, s56, 1024
    v_add_u32 v30, s57, v5
    v_add_u32 v5, 384, v8
    v_mul_u32_u24 v6, 2341, v5
    v_lshrrev_b32 v6, 16, v6
    v_mul_u32_u24 v7, 448, v6
    v_lshl_add_u32 v5, v5, 4, v7
    v_and_b32 v6, 8, v6
    v_lshlrev_b32 v6, 2, v6
    v_xor_b32 v5, v5, v6
    s_sub_u32 s57, s56, 2048
    v_add_u32 v31, s57, v5
    s_waitcnt lgkmcnt(0)
    s_mov_b32 s36, s4
    s_mov_b32 s37, s5
    s_mov_b32 s38, 1835008
    s_mov_b32 s39, 0x20000
    buffer_load_dwordx4 v[40:43], v16, s[36:39], 0 offen offset:0
    buffer_load_dwordx4 v[44:47], v16, s[36:39], 0 offen offset:256
    buffer_load_dwordx4 v[48:51], v16, s[36:39], 0 offen offset:512
    buffer_load_dwordx4 v[52:55], v17, s[36:39], 0 offen offset:768
    s_cmp_eq_u32 s94, 0
    s_cselect_b32 s40, s8, s10
    s_cselect_b32 s41, s9, s11
    s_cselect_b64 s[72:73], 0, -1
    s_mov_b32 s42, 25088
    s_mov_b32 s43, 0x20000
    s_add_u32 m0, s69, s70
    s_add_u32 s52, s68, s70
    buffer_load_dwordx4 v4, s[40:43], s52 offen lds
    s_mov_b32 s36, s26
    s_mov_b32 s37, s27
    s_mov_b32 s38, 256
    s_mov_b32 s39, 0x20000
    s_or_b32 s52, s60, 1
    s_lshl_b32 s52, s52, 4
    v_mov_b32 v5, s52
    buffer_store_dword v5, v18, s[36:39], 0 offen sc1
    s_add_u32 s70, s70, 1024
    s_cmp_eq_u32 s70, 7168
    s_cselect_b32 s70, 0, s70
    s_add_u32 m0, s69, s70
    s_add_u32 s52, s68, s70
    buffer_load_dwordx4 v4, s[40:43], s52 offen lds
    s_add_u32 s70, s70, 1024
    s_cmp_eq_u32 s70, 7168
    s_cselect_b32 s70, 0, s70
    s_add_u32 m0, s69, s70
    s_add_u32 s52, s68, s70
    buffer_load_dwordx4 v4, s[40:43], s52 offen lds
    s_add_u32 s70, s70, 1024
    s_cmp_eq_u32 s70, 7168
    s_cselect_b32 s70, 0, s70
    s_add_u32 m0, s69, s70
    s_add_u32 s52, s68, s70
    buffer_load_dwordx4 v4, s[40:43], s52 offen lds
    s_add_u32 s70, s70, 1024
    s_cmp_eq_u32 s70, 7168
    s_cselect_b32 s70, 0, s70
    s_add_u32 m0, s69, s70
    s_add_u32 s52, s68, s70
    buffer_load_dwordx4 v4, s[40:43], s52 offen lds
    s_add_u32 s70, s70, 1024
    s_cmp_eq_u32 s70, 7168
    s_cselect_b32 s70, 0, s70
    s_add_u32 m0, s69, s70
    s_add_u32 s52, s68, s70
    buffer_load_dwordx4 v4, s[40:43], s52 offen lds
    s_add_u32 s70, s70, 1024
    s_cmp_eq_u32 s70, 7168
    s_cselect_b32 s70, 0, s70
    s_add_u32 m0, s69, s70
    s_add_u32 s52, s68, s70
    buffer_load_dwordx4 v4, s[40:43], s52 offen lds
    s_mov_b32 s44, s6
    s_mov_b32 s45, s7
    s_mov_b32 s46, 401408
    s_mov_b32 s47, 0x20000
    s_mov_b32 s96, s12
    s_mov_b32 s97, s13
    s_mov_b32 s98, 401408
    s_mov_b32 s99, 0x20000
    s_mov_b32 s32, s28
    s_mov_b32 s33, s29
    s_mov_b32 s34, 19529728
    s_mov_b32 s35, 0x20000
    s_lshl_b32 s52, s30, 8
    s_add_u32 s52, s52, s2
    s_mul_i32 s56, s52, 2341
    s_lshr_b32 s56, s56, 16
    s_mul_i32 s57, s56, 27776
    s_lshl_b32 s67, s52, 5
    s_add_u32 s67, s67, s57
    s_lshl_b32 s66, s52, 10
    s_add_u32 s66, s66, 589824
    s_cmp_ge_u32 s52, 392
    s_cselect_b32 s67, s101, s67
    s_cselect_b32 s66, s101, s66
    s_lshl_b32 s53, s30, 10
    s_add_u32 s53, s53, 155264
    v_lshlrev_b32 v64, 3, v1
    v_add_u32 v64, s53, v64
    v_lshrrev_b32 v5, 5, v1
    v_bfe_u32 v6, v1, 3, 2
    v_bfe_u32 v7, v1, 1, 2
    v_lshl_add_u32 v7, v5, 2, v7
    v_lshl_add_u32 v7, v6, 3, v7
    v_mul_u32_u24 v19, 896, v7
    v_and_b32 v5, 1, v1
    v_lshl_add_u32 v19, v5, 4, v19
    s_mul_i32 s53, s30, 3648
    s_add_u32 s53, s53, 140672
    v_mul_u32_u24 v21, 912, v3
    v_lshl_add_u32 v21, v2, 4, v21
    v_add_u32 v21, s53, v21
    v_mul_u32_u24 v7, 912, v2
    v_lshl_add_u32 v7, v3, 4, v7
    v_add_u32 v7, 140672, v7
    s_and_b32 s54, s30, 1
    s_lshl_b32 s53, s54, 5
    s_add_u32 s53, s53, 114688
    v_bfe_u32 v5, v1, 2, 2
    v_lshl_add_u32 v5, v3, 3, v5
    v_mul_u32_u24 v8, 56, v5
    v_and_b32 v6, 3, v1
    v_lshl_add_u32 v8, v6, 3, v8
    v_add_u32 v8, s53, v8
    v_mov_b32 v5, 28
    s_lshl_b32 s52, s51, 7
    v_mad_u32_u24 v222, s52, v5, v8
    v_add_u32 v208, s52, v7
    s_add_u32 s52, s52, 64
    v_mad_u32_u24 v223, s52, v5, v8
    v_add_u32 v209, s52, v7
    s_add_u32 s52, s52, 64
    s_cmp_eq_u32 s52, 896
    s_cselect_b32 s52, 0, s52
    v_mad_u32_u24 v224, s52, v5, v8
    v_add_u32 v210, s52, v7
    s_add_u32 s52, s52, 64
    v_mad_u32_u24 v225, s52, v5, v8
    v_add_u32 v211, s52, v7
    s_add_u32 s52, s52, 64
    s_cmp_eq_u32 s52, 896
    s_cselect_b32 s52, 0, s52
    v_mad_u32_u24 v226, s52, v5, v8
    v_add_u32 v212, s52, v7
    s_add_u32 s52, s52, 64
    v_mad_u32_u24 v227, s52, v5, v8
    v_add_u32 v213, s52, v7
    s_add_u32 s52, s52, 64
    s_cmp_eq_u32 s52, 896
    s_cselect_b32 s52, 0, s52
    v_mad_u32_u24 v228, s52, v5, v8
    v_add_u32 v214, s52, v7
    s_add_u32 s52, s52, 64
    v_mad_u32_u24 v229, s52, v5, v8
    v_add_u32 v215, s52, v7
    s_add_u32 s52, s52, 64
    s_cmp_eq_u32 s52, 896
    s_cselect_b32 s52, 0, s52
    v_mad_u32_u24 v230, s52, v5, v8
    v_add_u32 v216, s52, v7
    s_add_u32 s52, s52, 64
    v_mad_u32_u24 v231, s52, v5, v8
    v_add_u32 v217, s52, v7
    s_add_u32 s52, s52, 64
    s_cmp_eq_u32 s52, 896
    s_cselect_b32 s52, 0, s52
    v_mad_u32_u24 v232, s52, v5, v8
    v_add_u32 v218, s52, v7
    s_add_u32 s52, s52, 64
    v_mad_u32_u24 v233, s52, v5, v8
    v_add_u32 v219, s52, v7
    s_add_u32 s52, s52, 64
    s_cmp_eq_u32 s52, 896
    s_cselect_b32 s52, 0, s52
    v_mad_u32_u24 v234, s52, v5, v8
    v_add_u32 v220, s52, v7
    s_add_u32 s52, s52, 64
    v_mad_u32_u24 v235, s52, v5, v8
    v_add_u32 v221, s52, v7
    s_lshr_b32 s52, s95, 1
    s_lshl_b32 s52, s52, 12
    s_add_u32 s52, s52, 327680
    s_and_b32 s53, s95, 1
    s_lshl_b32 s55, s54, 10
    s_lshl_b32 s56, s53, 8
    s_add_u32 s55, s55, s56
    s_lshl_b32 s56, s53, 10
    s_lshl_b32 s57, s54, 8
    s_add_u32 s56, s56, s57
    s_add_u32 s56, s56, 2048
    s_cmp_eq_u32 s94, 0
    s_cselect_b32 s55, s55, s56
    s_add_u32 s52, s52, s55
    s_cmp_ge_u32 s30, 2
    s_cselect_b32 s52, s101, s52
    v_lshrrev_b32 v5, 1, v3
    v_and_b32 v6, 1, v3
    v_cndmask_b32 v7, v5, v6, s[72:73]
    v_cndmask_b32 v8, v6, v5, s[72:73]
    v_lshlrev_b32 v7, 9, v7
    v_lshl_add_u32 v7, v8, 3, v7
    v_lshl_add_u32 v7, v2, 4, v7
    v_add_u32 v22, s52, v7
    v_cmp_eq_u32 s[56:57], 3, v3
    v_cmp_le_u32 s[60:61], 12, v2
    v_mov_b32 v5, 0x3f803f80
    v_mov_b32 v6, 0x00003f80
    v_cmp_eq_u32 vcc, 12, v2
    s_nop 1
    v_cndmask_b32 v7, 0, v5, vcc
    v_cndmask_b32 v23, v5, v7, s[72:73]
    v_cndmask_b32 v24, v6, v7, s[72:73]
    s_cmp_eq_u32 s94, 1
    s_cselect_b64 s[74:75], s[60:61], s[56:57]
    s_cmp_eq_u32 s54, 1
    s_cselect_b64 s[74:75], s[74:75], 0
    s_lshl_b32 s53, s30, 16
    s_lshl_b32 s54, s49, 12
    s_and_b32 s54, s54, 0xf000
    s_add_u32 s54, s54, 327680
    s_add_u32 s78, s54, s53
    s_xor_b32 s79, s78, 4096
    s_xor_b32 s80, s78, 8192
    s_xor_b32 s81, s78, 12288
    s_xor_b32 s82, s78, 16384
    s_xor_b32 s83, s78, 20480
    s_xor_b32 s84, s78, 24576
    s_xor_b32 s85, s78, 28672
    s_xor_b32 s86, s78, 32768
    s_xor_b32 s87, s78, 36864
    s_xor_b32 s88, s78, 40960
    s_xor_b32 s89, s78, 45056
    s_xor_b32 s90, s78, 49152
    s_xor_b32 s91, s78, 53248
    s_xor_b32 s92, s78, 57344
    s_xor_b32 s93, s78, 61440
    s_branch L_pg0
.p2align 12
L_pg0:
    s_waitcnt vmcnt(8)
    v_lshlrev_b32 v128, 16, v40
    v_and_b32 v129, 0xffff0000, v40
    v_lshlrev_b32 v130, 16, v41
    v_and_b32 v131, 0xffff0000, v41
    v_lshlrev_b32 v132, 16, v42
    v_and_b32 v133, 0xffff0000, v42
    v_lshlrev_b32 v134, 16, v43
    v_and_b32 v135, 0xffff0000, v43
    v_lshlrev_b32 v136, 16, v44
    v_and_b32 v137, 0xffff0000, v44
    v_lshlrev_b32 v138, 16, v45
    v_and_b32 v139, 0xffff0000, v45
    v_lshlrev_b32 v140, 16, v46
    v_and_b32 v141, 0xffff0000, v46
    v_lshlrev_b32 v142, 16, v47
    v_and_b32 v143, 0xffff0000, v47
    s_add_u32 m0, s64, 0
    s_nop 0
    buffer_load_dwordx4 v25, s[44:47], s65 offen offset:0 lds
    v_lshlrev_b32 v144, 16, v48
    v_and_b32 v145, 0xffff0000, v48
    v_lshlrev_b32 v146, 16, v49
    v_and_b32 v147, 0xffff0000, v49
    v_lshlrev_b32 v148, 16, v50
    v_and_b32 v149, 0xffff0000, v50
    v_lshlrev_b32 v150, 16, v51
    v_and_b32 v151, 0xffff0000, v51
    v_lshlrev_b32 v152, 16, v52
    v_and_b32 v153, 0xffff0000, v52
    v_lshlrev_b32 v154, 16, v53
    v_and_b32 v155, 0xffff0000, v53
    v_lshlrev_b32 v156, 16, v54
    v_and_b32 v157, 0xffff0000, v54
    v_lshlrev_b32 v158, 16, v55
    v_and_b32 v159, 0xffff0000, v55
    buffer_load_dwordx4 v26, s[44:47], s65 offen offset:1024 lds
    v_pk_add_f32 v[56:57], v[128:129], v[130:131]
    v_pk_mul_f32 v[58:59], v[128:129], v[128:129]
    v_pk_fma_f32 v[58:59], v[130:131], v[130:131], v[58:59]
    v_pk_add_f32 v[56:57], v[56:57], v[132:133]
    v_pk_fma_f32 v[58:59], v[132:133], v[132:133], v[58:59]
    v_pk_add_f32 v[56:57], v[56:57], v[134:135]
    v_pk_fma_f32 v[58:59], v[134:135], v[134:135], v[58:59]
    v_pk_add_f32 v[56:57], v[56:57], v[136:137]
    v_pk_fma_f32 v[58:59], v[136:137], v[136:137], v[58:59]
    v_pk_add_f32 v[56:57], v[56:57], v[138:139]
    v_pk_fma_f32 v[58:59], v[138:139], v[138:139], v[58:59]
    v_pk_add_f32 v[56:57], v[56:57], v[140:141]
    v_pk_fma_f32 v[58:59], v[140:141], v[140:141], v[58:59]
    v_pk_add_f32 v[56:57], v[56:57], v[142:143]
    v_pk_fma_f32 v[58:59], v[142:143], v[142:143], v[58:59]
    buffer_load_dwordx4 v27, s[44:47], s65 offen offset:2048 lds
    v_pk_add_f32 v[56:57], v[56:57], v[144:145]
    v_pk_fma_f32 v[58:59], v[144:145], v[144:145], v[58:59]
    v_pk_add_f32 v[56:57], v[56:57], v[146:147]
    v_pk_fma_f32 v[58:59], v[146:147], v[146:147], v[58:59]
    v_pk_add_f32 v[56:57], v[56:57], v[148:149]
    v_pk_fma_f32 v[58:59], v[148:149], v[148:149], v[58:59]
    v_pk_add_f32 v[56:57], v[56:57], v[150:151]
    v_pk_fma_f32 v[58:59], v[150:151], v[150:151], v[58:59]
    v_pk_add_f32 v[56:57], v[56:57], v[152:153]
    v_pk_fma_f32 v[58:59], v[152:153], v[152:153], v[58:59]
    v_pk_add_f32 v[56:57], v[56:57], v[154:155]
    v_pk_fma_f32 v[58:59], v[154:155], v[154:155], v[58:59]
    v_pk_add_f32 v[56:57], v[56:57], v[156:157]
    v_pk_fma_f32 v[58:59], v[156:157], v[156:157], v[58:59]
    v_pk_add_f32 v[56:57], v[56:57], v[158:159]
    v_pk_fma_f32 v[58:59], v[158:159], v[158:159], v[58:59]
    buffer_load_dwordx4 v28, s[44:47], s65 offen offset:3072 lds
    v_add_f32 v56, v56, v57
    v_add_f32 v58, v58, v59
    s_nop 0
    v_add_f32_dpp v56, v56, v56 row_ror:8 row_mask:0xf bank_mask:0xf
    v_add_f32_dpp v58, v58, v58 row_ror:8 row_mask:0xf bank_mask:0xf
    s_nop 0
    v_add_f32_dpp v56, v56, v56 row_ror:4 row_mask:0xf bank_mask:0xf
    v_add_f32_dpp v58, v58, v58 row_ror:4 row_mask:0xf bank_mask:0xf
    s_nop 0
    v_add_f32_dpp v56, v56, v56 row_ror:2 row_mask:0xf bank_mask:0xf
    v_add_f32_dpp v58, v58, v58 row_ror:2 row_mask:0xf bank_mask:0xf
    s_nop 0
    v_add_f32_dpp v56, v56, v56 row_ror:1 row_mask:0xf bank_mask:0xf
    v_add_f32_dpp v58, v58, v58 row_ror:1 row_mask:0xf bank_mask:0xf
    s_add_u32 m0, s64, 4096
    s_nop 0
    buffer_load_dwordx4 v29, s[44:47], s65 offen offset:0 lds
    v_mul_f32 v56, 0x3b124925, v56
    v_mul_f32 v58, 0x3b124925, v58
    v_fma_f32 v58, -v56, v56, v58
    v_max_f32 v58, 0, v58
    v_cvt_pk_bf16_f32 v58, v58, v58
    v_lshlrev_b32 v58, 16, v58
    v_add_f32 v58, 0x3727c5ac, v58
    v_cvt_pk_bf16_f32 v58, v58, v58
    v_lshlrev_b32 v58, 16, v58
    v_sqrt_f32 v58, v58
    v_cvt_pk_bf16_f32 v56, v56, v56
    v_lshlrev_b32 v56, 16, v56
    v_cvt_pk_bf16_f32 v58, v58, v58
    v_lshlrev_b32 v58, 16, v58
    v_rcp_f32 v60, v58
    buffer_load_dwordx4 v30, s[44:47], s65 offen offset:1024 lds
    v_mul_f32 v62, -v56, v60
    v_pk_fma_f32 v[128:129], v[128:129], v[60:61], v[62:63] op_sel_hi:[1,0,0]
    v_pk_fma_f32 v[130:131], v[130:131], v[60:61], v[62:63] op_sel_hi:[1,0,0]
    v_pk_fma_f32 v[132:133], v[132:133], v[60:61], v[62:63] op_sel_hi:[1,0,0]
    v_pk_fma_f32 v[134:135], v[134:135], v[60:61], v[62:63] op_sel_hi:[1,0,0]
    v_cvt_pk_bf16_f32 v160, v128, v129
    v_cvt_pk_bf16_f32 v161, v130, v131
    v_cvt_pk_bf16_f32 v162, v132, v133
    v_cvt_pk_bf16_f32 v163, v134, v135
    ds_write_b128 v21, v[160:163] offset:0
    v_pk_fma_f32 v[136:137], v[136:137], v[60:61], v[62:63] op_sel_hi:[1,0,0]
    v_pk_fma_f32 v[138:139], v[138:139], v[60:61], v[62:63] op_sel_hi:[1,0,0]
    v_pk_fma_f32 v[140:141], v[140:141], v[60:61], v[62:63] op_sel_hi:[1,0,0]
    v_pk_fma_f32 v[142:143], v[142:143], v[60:61], v[62:63] op_sel_hi:[1,0,0]
    v_cvt_pk_bf16_f32 v164, v136, v137
    v_cvt_pk_bf16_f32 v165, v138, v139
    v_cvt_pk_bf16_f32 v166, v140, v141
    v_cvt_pk_bf16_f32 v167, v142, v143
    ds_write_b128 v21, v[164:167] offset:256
    buffer_load_dwordx4 v31, s[44:47], s65 offen offset:2048 lds
    v_pk_fma_f32 v[144:145], v[144:145], v[60:61], v[62:63] op_sel_hi:[1,0,0]
    v_pk_fma_f32 v[146:147], v[146:147], v[60:61], v[62:63] op_sel_hi:[1,0,0]
    v_pk_fma_f32 v[148:149], v[148:149], v[60:61], v[62:63] op_sel_hi:[1,0,0]
    v_pk_fma_f32 v[150:151], v[150:151], v[60:61], v[62:63] op_sel_hi:[1,0,0]
    v_cvt_pk_bf16_f32 v168, v144, v145
    v_cvt_pk_bf16_f32 v169, v146, v147
    v_cvt_pk_bf16_f32 v170, v148, v149
    v_cvt_pk_bf16_f32 v171, v150, v151
    ds_write_b128 v21, v[168:171] offset:512
    v_pk_fma_f32 v[152:153], v[152:153], v[60:61], v[62:63] op_sel_hi:[1,0,0]
    v_pk_fma_f32 v[154:155], v[154:155], v[60:61], v[62:63] op_sel_hi:[1,0,0]
    v_pk_fma_f32 v[156:157], v[156:157], v[60:61], v[62:63] op_sel_hi:[1,0,0]
    v_pk_fma_f32 v[158:159], v[158:159], v[60:61], v[62:63] op_sel_hi:[1,0,0]
    v_cvt_pk_bf16_f32 v172, v152, v153
    v_cvt_pk_bf16_f32 v173, v154, v155
    v_cvt_pk_bf16_f32 v174, v156, v157
    v_cvt_pk_bf16_f32 v175, v158, v159
    s_mov_b64 exec, s[62:63]
    ds_write_b128 v21, v[172:175] offset:768
    s_mov_b64 exec, -1
    s_lshl_b32 s52, s30, 10
    s_add_u32 m0, s52, 155264
    s_nop 0
    buffer_load_dwordx4 v19, s[96:99], s67 offen lds
    s_waitcnt vmcnt(8)
    s_waitcnt lgkmcnt(0)
    s_barrier
    ds_read_b128 v[72:75], v208
    ds_read_b64_tr_b16 v[128:129], v222 offset:0
    ds_read_b64_tr_b16 v[130:131], v222 offset:224
    ds_read_b128 v[76:79], v209
    ds_read_b64_tr_b16 v[132:133], v223 offset:0
    ds_read_b64_tr_b16 v[134:135], v223 offset:224
    ds_read_b128 v[80:83], v210
    ds_read_b64_tr_b16 v[136:137], v224 offset:0
    ds_read_b64_tr_b16 v[138:139], v224 offset:224
    ds_read_b128 v[84:87], v211
    ds_read_b64_tr_b16 v[140:141], v225 offset:0
    ds_read_b64_tr_b16 v[142:143], v225 offset:224
    ds_read_b128 v[88:91], v212
    ds_read_b64_tr_b16 v[144:145], v226 offset:0
    ds_read_b64_tr_b16 v[146:147], v226 offset:224
    s_waitcnt lgkmcnt(12)
    v_mfma_f32_16x16x32_bf16 v[184:187], v[128:131], v[72:75], 0
    s_add_u32 m0, s64, 28672
    s_add_u32 s65, s65, 57344
    s_cmp_eq_u32 s65, 401408
    s_cselect_b32 s65, 0, s65
    buffer_load_dwordx4 v25, s[44:47], s65 offen offset:0 lds
    v_mfma_f32_16x16x32_bf16 v[188:191], v[72:75], v[128:131], 0
    s_lshl_b32 s53, s30, 2
    s_mul_i32 s54, s30, 3
    s_add_u32 s54, s54, 2
    s_cmp_lt_u32 s30, 2
    s_cselect_b32 s53, s53, s54
    s_cselect_b32 s54, 3, 2
    s_add_u32 s54, s54, s53
    v_bfe_u32 v68, v1, 2, 2
    v_lshl_add_u32 v68, v3, 3, v68
    v_mul_u32_u24 v68, 448, v68
    v_and_b32 v69, 3, v1
    v_lshl_add_u32 v68, v69, 3, v68
    v_and_b32 v69, 1, v3
    v_mul_u32_u24 v67, 528, v2
    v_add_u32 v67, 16384, v67
    s_add_u32 s55, s53, 0
    ds_read_b128 v[92:95], v213
    ds_read_b64_tr_b16 v[148:149], v227 offset:0
    ds_read_b64_tr_b16 v[150:151], v227 offset:224
    s_waitcnt lgkmcnt(12)
    v_mfma_f32_16x16x32_bf16 v[184:187], v[132:135], v[76:79], v[184:187]
    buffer_load_dwordx4 v26, s[44:47], s65 offen offset:1024 lds
    v_mfma_f32_16x16x32_bf16 v[188:191], v[76:79], v[132:135], v[188:191]
    s_min_u32 s55, s55, s54
    v_xor_b32 v70, s55, v69
    v_lshl_add_u32 v236, v70, 5, v68
    v_add_u32 v240, 57344, v236
    s_lshl_b32 s55, s55, 4
    v_lshl_add_u32 v70, v3, 2, s55
    v_mul_u32_u24 v71, 2341, v70
    v_lshrrev_b32 v71, 16, v71
    v_lshl_add_u32 v70, v70, 1, v67
    v_lshl_add_u32 v32, v71, 3, v70
    s_add_u32 s55, s53, 1
    s_min_u32 s55, s55, s54
    v_xor_b32 v70, s55, v69
    v_lshl_add_u32 v237, v70, 5, v68
    v_add_u32 v241, 57344, v237
    ds_read_b128 v[96:99], v214
    ds_read_b64_tr_b16 v[152:153], v228 offset:0
    ds_read_b64_tr_b16 v[154:155], v228 offset:224
    s_waitcnt lgkmcnt(12)
    v_mfma_f32_16x16x32_bf16 v[184:187], v[136:139], v[80:83], v[184:187]
    buffer_load_dwordx4 v27, s[44:47], s65 offen offset:2048 lds
    v_mfma_f32_16x16x32_bf16 v[188:191], v[80:83], v[136:139], v[188:191]
    s_lshl_b32 s55, s55, 4
    v_lshl_add_u32 v70, v3, 2, s55
    v_mul_u32_u24 v71, 2341, v70
    v_lshrrev_b32 v71, 16, v71
    v_lshl_add_u32 v70, v70, 1, v67
    v_lshl_add_u32 v33, v71, 3, v70
    s_add_u32 s55, s53, 2
    s_min_u32 s55, s55, s54
    v_xor_b32 v70, s55, v69
    v_lshl_add_u32 v238, v70, 5, v68
    v_add_u32 v242, 57344, v238
    s_lshl_b32 s55, s55, 4
    v_lshl_add_u32 v70, v3, 2, s55
    v_mul_u32_u24 v71, 2341, v70
    v_lshrrev_b32 v71, 16, v71
    ds_read_b128 v[100:103], v215
    ds_read_b64_tr_b16 v[156:157], v229 offset:0
    ds_read_b64_tr_b16 v[158:159], v229 offset:224
    s_waitcnt lgkmcnt(12)
    v_mfma_f32_16x16x32_bf16 v[184:187], v[140:143], v[84:87], v[184:187]
    buffer_load_dwordx4 v28, s[44:47], s65 offen offset:3072 lds
    v_mfma_f32_16x16x32_bf16 v[188:191], v[84:87], v[140:143], v[188:191]
    v_lshl_add_u32 v70, v70, 1, v67
    v_lshl_add_u32 v34, v71, 3, v70
    s_add_u32 s55, s53, 3
    s_min_u32 s55, s55, s54
    v_xor_b32 v70, s55, v69
    v_lshl_add_u32 v239, v70, 5, v68
    v_add_u32 v243, 57344, v239
    s_lshl_b32 s55, s55, 4
    v_lshl_add_u32 v70, v3, 2, s55
    v_mul_u32_u24 v71, 2341, v70
    v_lshrrev_b32 v71, 16, v71
    v_lshl_add_u32 v70, v70, 1, v67
    v_lshl_add_u32 v35, v71, 3, v70
    s_lshl_b32 s55, s50, 4
    v_mov_b32 v68, s55
    ds_read_b128 v[104:107], v216
    ds_read_b64_tr_b16 v[160:161], v230 offset:0
    ds_read_b64_tr_b16 v[162:163], v230 offset:224
    s_waitcnt lgkmcnt(12)
    v_mfma_f32_16x16x32_bf16 v[184:187], v[144:147], v[88:91], v[184:187]
    s_add_u32 m0, s64, 32768
    s_nop 0
    buffer_load_dwordx4 v29, s[44:47], s65 offen offset:0 lds
    v_mfma_f32_16x16x32_bf16 v[188:191], v[88:91], v[144:147], v[188:191]
    v_mov_b32 v69, s101
    v_cmp_eq_u32 vcc, 0, v0
    s_nop 1
    v_cndmask_b32 v11, v69, v68, vcc
    v_lshlrev_b32 v10, 4, v0
    s_and_b32 s6, s49, 15
    s_lshr_b32 s7, s49, 4
    s_mul_i32 s8, s49, 9363
    s_lshr_b32 s8, s8, 16
    s_mul_i32 s9, s8, 7
    s_sub_u32 s9, s49, s9
    s_cmp_ge_u32 s6, 14
    s_cselect_b32 s10, 14, 0
    ds_read_b128 v[108:111], v217
    ds_read_b64_tr_b16 v[164:165], v231 offset:0
    ds_read_b64_tr_b16 v[166:167], v231 offset:224
    s_waitcnt lgkmcnt(12)
    v_mfma_f32_16x16x32_bf16 v[184:187], v[148:151], v[92:95], v[184:187]
    buffer_load_dwordx4 v30, s[44:47], s65 offen offset:1024 lds
    v_mfma_f32_16x16x32_bf16 v[188:191], v[92:95], v[148:151], v[188:191]
    s_sub_u32 s10, s6, s10
    s_mul_i32 s12, s9, 112
    s_mul_i32 s52, s30, 28
    s_add_u32 s12, s12, s52
    s_lshl_b32 s12, s12, 11
    s_add_u32 s12, s12, 2654208
    s_cmp_ge_u32 s49, 28
    s_cselect_b32 s12, s101, s12
    s_add_u32 s11, s12, 0
    s_add_u32 s58, s12, 14336
    s_add_u32 s59, s12, 28672
    s_add_u32 s26, s12, 43008
    ds_read_b128 v[112:115], v218
    ds_read_b64_tr_b16 v[168:169], v232 offset:0
    ds_read_b64_tr_b16 v[170:171], v232 offset:224
    s_waitcnt lgkmcnt(12)
    v_mfma_f32_16x16x32_bf16 v[184:187], v[152:155], v[96:99], v[184:187]
    buffer_load_dwordx4 v31, s[44:47], s65 offen offset:2048 lds
    v_mfma_f32_16x16x32_bf16 v[188:191], v[96:99], v[152:155], v[188:191]
    s_lshl_b32 s52, s50, 2
    s_add_u32 s52, s52, s30
    s_mov_b32 s77, 7168
    s_cmp_lt_u32 s52, 392
    s_cselect_b32 s55, 0, 392
    s_cselect_b32 s53, 14, 56
    s_cselect_b32 s54, 16, 18
    s_cselect_b32 s77, 28672, s77
    s_cselect_b32 s40, s16, s20
    s_cselect_b32 s41, s17, s21
    s_cselect_b64 s[68:69], 0, -1
    s_sub_u32 s55, s52, s55
    s_mul_i32 s57, s55, 4682
    s_lshr_b32 s57, s57, s54
    s_mul_i32 s53, s57, s53
    s_sub_u32 s56, s55, s53
    s_mov_b32 s42, 1605632
    s_mul_i32 s71, s56, s77
    s_lshl_b32 s71, s71, 2
    ds_read_b128 v[116:119], v219
    ds_read_b64_tr_b16 v[172:173], v233 offset:0
    ds_read_b64_tr_b16 v[174:175], v233 offset:224
    s_waitcnt lgkmcnt(12)
    v_mfma_f32_16x16x32_bf16 v[184:187], v[156:159], v[100:103], v[184:187]
    s_add_u32 m0, s64, 57344
    s_add_u32 s65, s65, 57344
    s_cmp_eq_u32 s65, 401408
    s_cselect_b32 s65, 0, s65
    buffer_load_dwordx4 v25, s[44:47], s65 offen offset:0 lds
    v_mfma_f32_16x16x32_bf16 v[188:191], v[100:103], v[156:159], v[188:191]
    s_lshl_b32 s53, s57, 12
    s_add_u32 s76, s53, s71
    s_add_u32 s76, s76, 1048576
    s_lshl_b32 s53, s57, 7
    s_add_u32 s71, s71, s53
    s_mul_i32 s53, s57, 229376
    s_lshl_b32 s54, s56, 12
    s_add_u32 s53, s53, s54
    s_add_u32 s53, s53, 2654208
    s_lshl_b32 s13, s30, 12
    s_cmp_ge_u32 s52, 392
    s_cselect_b32 s76, s53, s76
    ds_read_b128 v[120:123], v220
    ds_read_b64_tr_b16 v[176:177], v234 offset:0
    ds_read_b64_tr_b16 v[178:179], v234 offset:224
    s_waitcnt lgkmcnt(12)
    v_mfma_f32_16x16x32_bf16 v[184:187], v[160:163], v[104:107], v[184:187]
    buffer_load_dwordx4 v26, s[44:47], s65 offen offset:1024 lds
    v_mfma_f32_16x16x32_bf16 v[188:191], v[104:107], v[160:163], v[188:191]
    s_cmp_ge_u32 s52, 784
    s_cselect_b32 s71, s101, s71
    s_cselect_b32 s76, s101, s76
    s_mul_i32 s56, s6, 7168
    s_add_u32 s56, s56, 1048576
    s_add_u32 s54, s10, 0
    s_add_u32 s54, s54, s30
    s_sub_u32 s55, s54, 14
    s_min_u32 s54, s54, s55
    s_mul_i32 s54, s54, 114688
    s_add_u32 s16, s54, s56
    s_add_u32 s54, s10, 4
    ds_read_b128 v[124:127], v221
    ds_read_b64_tr_b16 v[180:181], v235 offset:0
    ds_read_b64_tr_b16 v[182:183], v235 offset:224
    s_waitcnt lgkmcnt(12)
    v_mfma_f32_16x16x32_bf16 v[184:187], v[164:167], v[108:111], v[184:187]
    buffer_load_dwordx4 v27, s[44:47], s65 offen offset:2048 lds
    v_mfma_f32_16x16x32_bf16 v[188:191], v[108:111], v[164:167], v[188:191]
    s_add_u32 s54, s54, s30
    s_sub_u32 s55, s54, 14
    s_min_u32 s54, s54, s55
    s_mul_i32 s54, s54, 114688
    s_add_u32 s17, s54, s56
    s_add_u32 s54, s10, 8
    s_add_u32 s54, s54, s30
    s_sub_u32 s55, s54, 14
    s_min_u32 s54, s54, s55
    s_mul_i32 s54, s54, 114688
    s_add_u32 s20, s54, s56
    s_lshr_b32 s53, s30, 1
    s_waitcnt lgkmcnt(9)
    v_mfma_f32_16x16x32_bf16 v[184:187], v[168:171], v[112:115], v[184:187]
    buffer_load_dwordx4 v28, s[44:47], s65 offen offset:3072 lds
    v_mfma_f32_16x16x32_bf16 v[188:191], v[112:115], v[168:171], v[188:191]
    s_add_u32 s54, s10, 12
    s_add_u32 s54, s54, s53
    s_sub_u32 s55, s54, 14
    s_min_u32 s54, s54, s55
    s_mul_i32 s54, s54, 114688
    s_add_u32 s21, s54, s56
    s_and_b32 s53, s30, 1
    s_lshl_b32 s53, s53, 12
    s_add_u32 s21, s21, s53
    s_lshl_b32 s52, s48, 3
    s_lshl_b32 s53, s7, 2
    s_add_u32 s52, s52, s53
    s_waitcnt lgkmcnt(6)
    v_mfma_f32_16x16x32_bf16 v[184:187], v[172:175], v[116:119], v[184:187]
    s_add_u32 m0, s64, 61440
    s_nop 0
    buffer_load_dwordx4 v29, s[44:47], s65 offen offset:0 lds
    v_mfma_f32_16x16x32_bf16 v[188:191], v[116:119], v[172:175], v[188:191]
    s_add_u32 s52, s52, s30
    s_mul_i32 s52, s52, 112
    s_mul_i32 s53, s6, 7
    s_add_u32 s52, s52, s53
    s_lshl_b32 s52, s52, 10
    s_add_u32 s97, s52, 7995392
    s_waitcnt lgkmcnt(3)
    v_mfma_f32_16x16x32_bf16 v[184:187], v[176:179], v[120:123], v[184:187]
    buffer_load_dwordx4 v30, s[44:47], s65 offen offset:1024 lds
    v_mfma_f32_16x16x32_bf16 v[188:191], v[120:123], v[176:179], v[188:191]
    s_waitcnt lgkmcnt(0)
    v_mfma_f32_16x16x32_bf16 v[184:187], v[180:183], v[124:127], v[184:187]
    buffer_load_dwordx4 v31, s[44:47], s65 offen offset:2048 lds
    v_mfma_f32_16x16x32_bf16 v[188:191], v[124:127], v[180:183], v[188:191]
    v_mov_b32 v7, 0
    s_nop 4
    v_cvt_pk_bf16_f32 v56, v184, v185
    v_cvt_pk_bf16_f32 v57, v186, v187
    v_cvt_pk_bf16_f32 v58, v188, v189
    v_cvt_pk_bf16_f32 v59, v190, v191
    v_cndmask_b32 v56, v56, v58, s[72:73]
    v_cndmask_b32 v57, v57, v59, s[72:73]
    v_cndmask_b32 v56, v56, v23, s[74:75]
    v_cndmask_b32 v57, v57, v24, s[74:75]
    buffer_store_dwordx2 v[56:57], v22, s[32:35], 0 offen sc1
    buffer_load_dword v9, v7, s[36:39], 0 offen sc1
    s_waitcnt vmcnt(17)
    s_barrier
    s_add_u32 m0, s64, 86016
    s_add_u32 s65, s65, 57344
    s_cmp_eq_u32 s65, 401408
    s_cselect_b32 s65, 0, s65
    buffer_load_dwordx4 v25, s[44:47], s65 offen offset:0 lds
    ds_read_b64_tr_b16 v[128:129], v236 offset:0
    ds_read_b64_tr_b16 v[130:131], v236 offset:1792
    ds_read_b64_tr_b16 v[132:133], v237 offset:0
    ds_read_b64_tr_b16 v[134:135], v237 offset:1792
    buffer_load_dwordx4 v26, s[44:47], s65 offen offset:1024 lds
    ds_read_b64_tr_b16 v[136:137], v238 offset:0
    ds_read_b64_tr_b16 v[138:139], v238 offset:1792
    ds_read_b64_tr_b16 v[140:141], v239 offset:0
    ds_read_b64_tr_b16 v[142:143], v239 offset:1792
    buffer_load_dwordx4 v27, s[44:47], s65 offen offset:2048 lds
    ds_read_b64_tr_b16 v[144:145], v236 offset:14336
    ds_read_b64_tr_b16 v[146:147], v236 offset:16128
    ds_read_b64_tr_b16 v[148:149], v237 offset:14336
    ds_read_b64_tr_b16 v[150:151], v237 offset:16128
    buffer_load_dwordx4 v28, s[44:47], s65 offen offset:3072 lds
    ds_read_b64_tr_b16 v[152:153], v238 offset:14336
    ds_read_b64_tr_b16 v[154:155], v238 offset:16128
    ds_read_b64_tr_b16 v[156:157], v239 offset:14336
    ds_read_b64_tr_b16 v[158:159], v239 offset:16128
    s_waitcnt lgkmcnt(12)
    v_mfma_f32_16x16x32_bf16 v[192:195], v[128:131], v[72:75], 0
    v_mul_u32_u24 v224, 528, v2
    v_and_b32 v225, 1, v3
    v_lshl_add_u32 v224, v225, 6, v224
    v_lshrrev_b32 v225, 1, v3
    v_mfma_f32_16x16x32_bf16 v[196:199], v[132:135], v[72:75], 0
    v_lshl_add_u32 v224, v225, 4, v224
    v_add_u32 v224, 16384, v224
    s_add_u32 s52, s30, 1
    s_and_b32 s52, s52, 3
    s_add_u32 m0, s64, 90112
    s_nop 0
    buffer_load_dwordx4 v29, s[44:47], s65 offen offset:0 lds
    s_waitcnt lgkmcnt(8)
    v_mfma_f32_16x16x32_bf16 v[200:203], v[136:139], v[72:75], 0
    v_lshl_add_u32 v36, s52, 7, v224
    s_mul_i32 s53, s52, 12288
    v_add_u32 v220, s53, v4
    s_add_u32 s52, s30, 2
    v_mfma_f32_16x16x32_bf16 v[204:207], v[140:143], v[72:75], 0
    s_and_b32 s52, s52, 3
    v_lshl_add_u32 v37, s52, 7, v224
    s_mul_i32 s53, s52, 12288
    v_add_u32 v221, s53, v4
    s_waitcnt lgkmcnt(4)
    v_mfma_f32_16x16x32_bf16 v[192:195], v[144:147], v[76:79], v[192:195]
    s_add_u32 s52, s30, 3
    s_and_b32 s52, s52, 3
    v_lshl_add_u32 v38, s52, 7, v224
    s_mul_i32 s53, s52, 12288
    buffer_load_dwordx4 v30, s[44:47], s65 offen offset:1024 lds
    v_mfma_f32_16x16x32_bf16 v[196:199], v[148:151], v[76:79], v[196:199]
    v_add_u32 v222, s53, v4
    s_add_u32 s52, s30, 4
    s_and_b32 s52, s52, 3
    v_lshl_add_u32 v39, s52, 7, v224
    s_waitcnt lgkmcnt(0)
    v_mfma_f32_16x16x32_bf16 v[200:203], v[152:155], v[76:79], v[200:203]
    v_mfma_f32_16x16x32_bf16 v[204:207], v[156:159], v[76:79], v[204:207]
    buffer_load_dwordx4 v31, s[44:47], s65 offen offset:2048 lds
    s_waitcnt vmcnt(23)
    ds_read_b64_tr_b16 a[56:57], v64 offset:0
    ds_read_b64_tr_b16 a[58:59], v64 offset:512
    s_waitcnt vmcnt(7)
    v_readfirstlane_b32 s31, v9
    s_getreg_b32 s60, hwreg(HW_REG_XCC_ID, 0, 4)
    s_nop 0
    s_cmp_eq_u32 s31, 0
    s_cbranch_scc1 L_slown
L_backn:
    s_or_b32 s60, s60, s31
    v_mov_b32 v20, s60
    v_mov_b32 v12, s31
    s_mov_b32 s98, 4096
    s_mov_b32 s100, s60
    s_waitcnt lgkmcnt(0)
    s_barrier
    buffer_store_dword v20, v11, s[32:35], 0 offen sc1
    buffer_store_dwordx4 a[56:59], v4, s[32:35], s66 offen sc1
    s_add_u32 m0, s64, 0
    s_add_u32 s65, s65, 57344
    s_cmp_eq_u32 s65, 401408
    s_cselect_b32 s65, 0, s65
    buffer_load_dwordx4 v25, s[44:47], s65 offen offset:0 lds
    ds_read_b64_tr_b16 v[128:129], v236 offset:28672
    ds_read_b64_tr_b16 v[130:131], v236 offset:30464
    ds_read_b64_tr_b16 v[132:133], v237 offset:28672
    ds_read_b64_tr_b16 v[134:135], v237 offset:30464
    buffer_load_dwordx4 v26, s[44:47], s65 offen offset:1024 lds
    ds_read_b64_tr_b16 v[136:137], v238 offset:28672
    ds_read_b64_tr_b16 v[138:139], v238 offset:30464
    ds_read_b64_tr_b16 v[140:141], v239 offset:28672
    ds_read_b64_tr_b16 v[142:143], v239 offset:30464
    buffer_load_dwordx4 v27, s[44:47], s65 offen offset:2048 lds
    ds_read_b64_tr_b16 v[144:145], v236 offset:43008
    ds_read_b64_tr_b16 v[146:147], v236 offset:44800
    ds_read_b64_tr_b16 v[148:149], v237 offset:43008
    ds_read_b64_tr_b16 v[150:151], v237 offset:44800
    buffer_load_dwordx4 v28, s[44:47], s65 offen offset:3072 lds
    ds_read_b64_tr_b16 v[152:153], v238 offset:43008
    ds_read_b64_tr_b16 v[154:155], v238 offset:44800
    ds_read_b64_tr_b16 v[156:157], v239 offset:43008
    ds_read_b64_tr_b16 v[158:159], v239 offset:44800
    s_waitcnt lgkmcnt(12)
    v_mfma_f32_16x16x32_bf16 v[192:195], v[128:131], v[80:83], v[192:195]
    s_mul_i32 s53, s52, 12288
    v_add_u32 v223, s53, v4
    s_lshl_b32 s53, s30, 16
    s_sub_u32 s96, s78, s53
    v_mfma_f32_16x16x32_bf16 v[196:199], v[132:135], v[80:83], v[196:199]
    v_and_b32 v65, 31, v1
    v_lshlrev_b32 v65, 4, v65
    s_lshl_b32 s55, s48, 9
    v_add_u32 v65, s55, v65
    s_add_u32 m0, s64, 4096
    s_nop 0
    buffer_load_dwordx4 v29, s[44:47], s65 offen offset:0 lds
    s_waitcnt lgkmcnt(8)
    v_mfma_f32_16x16x32_bf16 v[200:203], v[136:139], v[80:83], v[200:203]
    s_lshr_b32 s52, s77, 3
    v_lshrrev_b32 v224, 3, v1
    v_mul_lo_u32 v252, v224, s52
    v_and_b32 v224, 7, v1
    v_mfma_f32_16x16x32_bf16 v[204:207], v[140:143], v[80:83], v[204:207]
    v_lshl_add_u32 v252, v224, 4, v252
    v_bfe_u32 v224, v1, 2, 2
    v_and_b32 v225, 3, v1
    v_lshlrev_b32 v225, 3, v225
    s_waitcnt lgkmcnt(4)
    v_mfma_f32_16x16x32_bf16 v[192:195], v[144:147], v[84:87], v[192:195]
    v_add_u32 v225, s13, v225
    v_lshl_add_u32 v226, v3, 3, v224
    v_lshl_add_u32 v226, v226, 7, v225
    v_lshrrev_b32 v227, 1, v3
    buffer_load_dwordx4 v30, s[44:47], s65 offen offset:1024 lds
    v_mfma_f32_16x16x32_bf16 v[196:199], v[148:151], v[84:87], v[196:199]
    v_lshl_add_u32 v224, v227, 2, v224
    v_lshl_add_u32 v224, v224, 7, v225
    v_and_b32 v227, 1, v3
    v_lshl_add_u32 v224, v227, 5, v224
    v_cndmask_b32 v244, v226, v224, s[68:69]
    s_waitcnt lgkmcnt(0)
    v_mfma_f32_16x16x32_bf16 v[200:203], v[152:155], v[84:87], v[200:203]
    v_mfma_f32_16x16x32_bf16 v[204:207], v[156:159], v[84:87], v[204:207]
    buffer_load_dwordx4 v31, s[44:47], s65 offen offset:2048 lds
    s_branch L_pg1
.p2align 12
L_pg1:
    s_barrier
    s_add_u32 m0, s64, 28672
    s_add_u32 s65, s65, 57344
    s_cmp_eq_u32 s65, 401408
    s_cselect_b32 s65, 0, s65
    buffer_load_dwordx4 v25, s[44:47], s65 offen offset:0 lds
    ds_read_b64_tr_b16 v[128:129], v240 offset:0
    ds_read_b64_tr_b16 v[130:131], v240 offset:1792
    ds_read_b64_tr_b16 v[132:133], v241 offset:0
    ds_read_b64_tr_b16 v[134:135], v241 offset:1792
    buffer_load_dwordx4 v26, s[44:47], s65 offen offset:1024 lds
    ds_read_b64_tr_b16 v[136:137], v242 offset:0
    ds_read_b64_tr_b16 v[138:139], v242 offset:1792
    ds_read_b64_tr_b16 v[140:141], v243 offset:0
    ds_read_b64_tr_b16 v[142:143], v243 offset:1792
    buffer_load_dwordx4 v27, s[44:47], s65 offen offset:2048 lds
    ds_read_b64_tr_b16 v[144:145], v240 offset:14336
    ds_read_b64_tr_b16 v[146:147], v240 offset:16128
    ds_read_b64_tr_b16 v[148:149], v241 offset:14336
    ds_read_b64_tr_b16 v[150:151], v241 offset:16128
    buffer_load_dwordx4 v28, s[44:47], s65 offen offset:3072 lds
    ds_read_b64_tr_b16 v[152:153], v242 offset:14336
    ds_read_b64_tr_b16 v[154:155], v242 offset:16128
    ds_read_b64_tr_b16 v[156:157], v243 offset:14336
    ds_read_b64_tr_b16 v[158:159], v243 offset:16128
    s_waitcnt lgkmcnt(12)
    v_mfma_f32_16x16x32_bf16 v[192:195], v[128:131], v[88:91], v[192:195]
    s_mov_b32 s52, 1024
    s_mov_b32 s54, 2048
    s_cmp_eq_u64 s[68:69], 0
    s_cselect_b32 s52, 512, s52
    s_cselect_b32 s53, 32, 64
    s_cselect_b32 s54, 64, s54
    v_add_u32 v245, s52, v244
    v_add_u32 v246, s53, v244
    v_add_u32 v247, s52, v246
    v_add_u32 v248, s54, v244
    v_mfma_f32_16x16x32_bf16 v[196:199], v[132:135], v[88:91], v[196:199]
    v_add_u32 v249, s52, v248
    v_add_u32 v250, s53, v248
    v_add_u32 v251, s52, v250
    s_mul_i32 s52, s6, 7
    s_lshr_b32 s52, s52, 2
    s_mul_i32 s52, s52, 14
    v_add_u32 v224, s52, v1
    v_min_u32 v224, 0x187, v224
    s_add_u32 m0, s64, 32768
    s_nop 0
    buffer_load_dwordx4 v29, s[44:47], s65 offen offset:0 lds
    s_waitcnt lgkmcnt(8)
    v_mfma_f32_16x16x32_bf16 v[200:203], v[136:139], v[88:91], v[200:203]
    s_mul_i32 s52, s9, 56
    s_mul_i32 s53, s30, 14
    s_add_u32 s52, s52, s53
    s_add_u32 s52, s52, 350
    v_mfma_f32_16x16x32_bf16 v[204:207], v[140:143], v[88:91], v[204:207]
    v_min_u32 v225, 55, v1
    v_add_u32 v225, s52, v225
    v_cmp_gt_u32 vcc, 42, v1
    s_nop 1
    v_cndmask_b32 v224, v225, v224, vcc
    s_waitcnt lgkmcnt(4)
    v_mfma_f32_16x16x32_bf16 v[192:195], v[144:147], v[92:95], v[192:195]
    v_lshlrev_b32 v218, 5, v224
    v_add_u32 v218, 65536, v218
    s_mul_i32 s52, s6, 224
    v_min_u32 v255, 6, v2
    buffer_load_dwordx4 v30, s[44:47], s65 offen offset:1024 lds
    v_mfma_f32_16x16x32_bf16 v[196:199], v[148:151], v[92:95], v[196:199]
    v_lshlrev_b32 v255, 5, v255
    v_lshl_add_u32 v255, v3, 3, v255
    v_add_u32 v255, s52, v255
    s_lshl_b32 s52, s9, 1
    s_waitcnt lgkmcnt(0)
    v_mfma_f32_16x16x32_bf16 v[200:203], v[152:155], v[92:95], v[200:203]
    s_lshr_b32 s53, s30, 1
    s_add_u32 s52, s52, s53
    s_lshl_b32 s52, s52, 6
    v_min_u32 v208, 3, v2
    v_mfma_f32_16x16x32_bf16 v[204:207], v[156:159], v[92:95], v[204:207]
    buffer_load_dwordx4 v31, s[44:47], s65 offen offset:2048 lds
    buffer_load_dword v9, v10, s[32:35], 0 offen sc1
    s_waitcnt vmcnt(17)
    s_waitcnt vmcnt(15)
    s_barrier
    buffer_store_dword v12, v11, s[32:35], s98 offen sc1
    s_add_u32 m0, s64, 57344
    s_add_u32 s65, s65, 57344
    s_cmp_eq_u32 s65, 401408
    s_cselect_b32 s65, 0, s65
    buffer_load_dwordx4 v25, s[44:47], s65 offen offset:0 lds
    ds_read_b64_tr_b16 v[128:129], v240 offset:28672
    ds_read_b64_tr_b16 v[130:131], v240 offset:30464
    ds_read_b64_tr_b16 v[132:133], v241 offset:28672
    ds_read_b64_tr_b16 v[134:135], v241 offset:30464
    buffer_load_dwordx4 v26, s[44:47], s65 offen offset:1024 lds
    ds_read_b64_tr_b16 v[136:137], v242 offset:28672
    ds_read_b64_tr_b16 v[138:139], v242 offset:30464
    ds_read_b64_tr_b16 v[140:141], v243 offset:28672
    ds_read_b64_tr_b16 v[142:143], v243 offset:30464
    buffer_load_dwordx4 v27, s[44:47], s65 offen offset:2048 lds
    ds_read_b64_tr_b16 v[144:145], v240 offset:43008
    ds_read_b64_tr_b16 v[146:147], v240 offset:44800
    ds_read_b64_tr_b16 v[148:149], v241 offset:43008
    ds_read_b64_tr_b16 v[150:151], v241 offset:44800
    buffer_load_dwordx4 v28, s[44:47], s65 offen offset:3072 lds
    ds_read_b64_tr_b16 v[152:153], v242 offset:43008
    ds_read_b64_tr_b16 v[154:155], v242 offset:44800
    ds_read_b64_tr_b16 v[156:157], v243 offset:43008
    ds_read_b64_tr_b16 v[158:159], v243 offset:44800
    s_waitcnt lgkmcnt(12)
    v_mfma_f32_16x16x32_bf16 v[192:195], v[128:131], v[96:99], v[192:195]
    v_lshrrev_b32 v224, 1, v3
    v_lshl_add_u32 v208, v208, 1, v224
    v_lshl_add_u32 v208, v208, 3, s52
    v_min_u32 v224, 48, v1
    v_mfma_f32_16x16x32_bf16 v[196:199], v[132:135], v[96:99], v[196:199]
    v_mul_u32_u24 v225, 37, v224
    v_lshrrev_b32 v225, 8, v225
    s_mul_i32 s52, s94, 196
    s_mul_i32 s53, s30, 7
    s_add_u32 m0, s64, 61440
    s_nop 0
    buffer_load_dwordx4 v29, s[44:47], s65 offen offset:0 lds
    s_waitcnt lgkmcnt(8)
    v_mfma_f32_16x16x32_bf16 v[200:203], v[136:139], v[96:99], v[200:203]
    s_add_u32 s52, s52, s53
    v_mad_u32_u24 v224, v225, 21, v224
    v_add_u32 v224, s52, v224
    v_and_b32 v225, 7, v224
    v_mfma_f32_16x16x32_bf16 v[204:207], v[140:143], v[96:99], v[204:207]
    v_bfe_u32 v224, v224, 3, 5
    v_lshl_add_u32 v224, v225, 5, v224
    v_lshlrev_b32 v224, 4, v224
    v_add_u32 v213, 4096, v224
    s_waitcnt lgkmcnt(4)
    v_mfma_f32_16x16x32_bf16 v[192:195], v[144:147], v[100:103], v[192:195]
    s_lshl_b32 s52, s48, 7
    s_lshl_b32 s53, s30, 5
    s_add_u32 s52, s52, s53
    s_lshl_b32 s52, s52, 4
    buffer_load_dwordx4 v30, s[44:47], s65 offen offset:1024 lds
    v_mfma_f32_16x16x32_bf16 v[196:199], v[148:151], v[100:103], v[196:199]
    s_add_u32 s52, s52, 131072
    v_and_b32 v224, 31, v1
    v_lshl_add_u32 v67, v224, 4, s52
    v_and_b32 v225, 7, v2
    s_waitcnt lgkmcnt(0)
    v_mfma_f32_16x16x32_bf16 v[200:203], v[152:155], v[100:103], v[200:203]
    v_mfma_f32_16x16x32_bf16 v[204:207], v[156:159], v[100:103], v[204:207]
    buffer_load_dwordx4 v31, s[44:47], s65 offen offset:2048 lds
    s_waitcnt vmcnt(16)
    s_waitcnt vmcnt(8)
    v_and_b32 v9, -16, v9
    v_cmp_ne_u32 vcc, s31, v9
    s_nop 1
    s_cbranch_vccnz L_slow0
L_back0:
    s_barrier
    buffer_load_dwordx4 a[48:51], v4, s[32:35], s96 offen offset:0 sc1
    ds_read_b64_tr_b16 v[128:129], v236 offset:0
    ds_read_b64_tr_b16 v[130:131], v236 offset:1792
    ds_read_b64_tr_b16 v[132:133], v237 offset:0
    ds_read_b64_tr_b16 v[134:135], v237 offset:1792
    buffer_load_dwordx4 a[52:55], v4, s[32:35], s96 offen offset:1024 sc1
    ds_read_b64_tr_b16 v[136:137], v238 offset:0
    ds_read_b64_tr_b16 v[138:139], v238 offset:1792
    ds_read_b64_tr_b16 v[140:141], v239 offset:0
    ds_read_b64_tr_b16 v[142:143], v239 offset:1792
    buffer_load_dwordx4 a[0:3], v4, s[32:35], s78 offen offset:0 sc1
    ds_read_b64_tr_b16 v[144:145], v236 offset:14336
    ds_read_b64_tr_b16 v[146:147], v236 offset:16128
    ds_read_b64_tr_b16 v[148:149], v237 offset:14336
    ds_read_b64_tr_b16 v[150:151], v237 offset:16128
    buffer_load_dwordx4 a[4:7], v4, s[32:35], s78 offen offset:1024 sc1
    ds_read_b64_tr_b16 v[152:153], v238 offset:14336
    ds_read_b64_tr_b16 v[154:155], v238 offset:16128
    ds_read_b64_tr_b16 v[156:157], v239 offset:14336
    ds_read_b64_tr_b16 v[158:159], v239 offset:16128
    s_waitcnt lgkmcnt(12)
    v_mfma_f32_16x16x32_bf16 v[192:195], v[128:131], v[104:107], v[192:195]
    v_mov_b32 v227, s101
    s_xor_b32 s52, s50, 1
    s_lshl_b32 s52, s52, 2
    s_add_u32 s52, s52, s30
    v_mfma_f32_16x16x32_bf16 v[196:199], v[132:135], v[104:107], v[196:199]
    s_lshl_b32 s52, s52, 11
    s_add_u32 s70, s52, 15335424
    s_xor_b32 s52, s70, 8192
    v_xor_b32 v209, 128, v4
    buffer_load_dwordx4 a[8:11], v4, s[32:35], s78 offen offset:2048 sc1
    s_waitcnt lgkmcnt(8)
    v_mfma_f32_16x16x32_bf16 v[200:203], v[136:139], v[104:107], v[200:203]
    v_add_u32 v209, s52, v209
    s_mul_i32 s53, s50, 7168
    s_mul_i32 s54, s30, 224
    s_add_u32 s53, s53, s54
    v_mfma_f32_16x16x32_bf16 v[204:207], v[140:143], v[104:107], v[204:207]
    v_mul_u32_u24 v219, 896, v225
    v_lshl_add_u32 v219, v3, 3, v219
    v_and_b32 v224, 8, v2
    v_lshl_add_u32 v219, v224, 3, v219
    s_waitcnt lgkmcnt(4)
    v_mfma_f32_16x16x32_bf16 v[192:195], v[144:147], v[108:111], v[192:195]
    v_add_u32 v219, s53, v219
    v_and_b32 v224, 7, v1
    v_lshrrev_b32 v225, 3, v1
    s_mul_i32 s52, s95, 14336
    v_mfma_f32_16x16x32_bf16 v[196:199], v[148:151], v[108:111], v[196:199]
    s_lshl_b32 s53, s94, 7
    s_add_u32 s52, s52, s53
    s_mul_i32 s53, s30, 3584
    s_add_u32 s52, s52, s53
    s_waitcnt lgkmcnt(0)
    v_mfma_f32_16x16x32_bf16 v[200:203], v[152:155], v[108:111], v[200:203]
    v_mfma_f32_16x16x32_bf16 v[204:207], v[156:159], v[108:111], v[204:207]
    buffer_load_dword v212, v65, s[32:35], 0 offen sc1
    s_barrier
    buffer_load_dwordx4 a[12:15], v4, s[32:35], s78 offen offset:3072 sc1
    ds_read_b64_tr_b16 v[128:129], v236 offset:28672
    ds_read_b64_tr_b16 v[130:131], v236 offset:30464
    ds_read_b64_tr_b16 v[132:133], v237 offset:28672
    ds_read_b64_tr_b16 v[134:135], v237 offset:30464
    buffer_load_dwordx4 a[16:19], v4, s[32:35], s79 offen offset:0 sc1
    ds_read_b64_tr_b16 v[136:137], v238 offset:28672
    ds_read_b64_tr_b16 v[138:139], v238 offset:30464
    ds_read_b64_tr_b16 v[140:141], v239 offset:28672
    ds_read_b64_tr_b16 v[142:143], v239 offset:30464
    buffer_load_dwordx4 a[20:23], v4, s[32:35], s79 offen offset:1024 sc1
    ds_read_b64_tr_b16 v[144:145], v236 offset:43008
    ds_read_b64_tr_b16 v[146:147], v236 offset:44800
    ds_read_b64_tr_b16 v[148:149], v237 offset:43008
    ds_read_b64_tr_b16 v[150:151], v237 offset:44800
    buffer_load_dwordx4 a[24:27], v4, s[32:35], s79 offen offset:2048 sc1
    ds_read_b64_tr_b16 v[152:153], v238 offset:43008
    ds_read_b64_tr_b16 v[154:155], v238 offset:44800
    ds_read_b64_tr_b16 v[156:157], v239 offset:43008
    ds_read_b64_tr_b16 v[158:159], v239 offset:44800
    s_waitcnt lgkmcnt(12)
    v_mfma_f32_16x16x32_bf16 v[192:195], v[128:131], v[112:115], v[192:195]
    v_lshlrev_b32 v216, 4, v224
    v_lshl_add_u32 v216, v225, 8, v216
    v_add_u32 v216, s52, v216
    v_cmp_gt_u32 vcc, 6, v225
    s_nop 1
    v_cndmask_b32 v217, v227, v216, vcc
    v_mfma_f32_16x16x32_bf16 v[196:199], v[132:135], v[112:115], v[196:199]
    v_mul_u32_u24 v224, 464, v2
    s_lshl_b32 s52, s94, 3
    v_xor_b32 v225, s52, v2
    v_mul_u32_u24 v211, 464, v225
    s_waitcnt lgkmcnt(8)
    v_mfma_f32_16x16x32_bf16 v[200:203], v[136:139], v[112:115], v[200:203]
    v_lshl_add_u32 v211, v3, 4, v211
    v_add_u32 v211, 149504, v211
    v_and_b32 v225, 1, v3
    v_mad_u32_u24 v224, v225, 56, v224
    v_mfma_f32_16x16x32_bf16 v[204:207], v[140:143], v[112:115], v[204:207]
    v_lshrrev_b32 v225, 1, v3
    v_lshl_add_u32 v224, v225, 3, v224
    s_mul_i32 s52, s30, 112
    s_add_u32 s52, s52, 149504
    s_waitcnt lgkmcnt(4)
    v_mfma_f32_16x16x32_bf16 v[192:195], v[144:147], v[116:119], v[192:195]
    v_add_u32 v210, s52, v224
    v_mfma_f32_16x16x32_bf16 v[196:199], v[148:151], v[116:119], v[196:199]
    s_waitcnt lgkmcnt(0)
    v_mfma_f32_16x16x32_bf16 v[200:203], v[152:155], v[116:119], v[200:203]
    v_mfma_f32_16x16x32_bf16 v[204:207], v[156:159], v[116:119], v[204:207]
    buffer_load_dwordx4 a[28:31], v4, s[32:35], s79 offen offset:3072 sc1
    s_waitcnt vmcnt(11)
    s_barrier
    buffer_load_dwordx4 a[32:35], v4, s[32:35], s80 offen offset:0 sc1
    ds_read_b64_tr_b16 v[128:129], v240 offset:0
    ds_read_b64_tr_b16 v[130:131], v240 offset:1792
    buffer_load_dwordx4 a[36:39], v4, s[32:35], s80 offen offset:1024 sc1
    ds_read_b64_tr_b16 v[132:133], v241 offset:0
    ds_read_b64_tr_b16 v[134:135], v241 offset:1792
    buffer_load_dwordx4 a[40:43], v4, s[32:35], s80 offen offset:2048 sc1
    ds_read_b64_tr_b16 v[136:137], v242 offset:0
    ds_read_b64_tr_b16 v[138:139], v242 offset:1792
    buffer_load_dwordx4 a[44:47], v4, s[32:35], s80 offen offset:3072 sc1
    ds_read_b64_tr_b16 v[140:141], v243 offset:0
    ds_read_b64_tr_b16 v[142:143], v243 offset:1792
    s_mov_b32 s36, s18
    s_mov_b32 s37, s19
    s_mov_b32 s38, 3584
    buffer_load_dwordx2 v[214:215], v255, s[36:39], 0 offen
    ds_read_b64_tr_b16 v[144:145], v240 offset:14336
    ds_read_b64_tr_b16 v[146:147], v240 offset:16128
    s_mov_b32 s44, s22
    s_mov_b32 s45, s23
    s_mov_b32 s46, 896
    buffer_load_dword v15, v208, s[44:47], 0 offen
    ds_read_b64_tr_b16 v[148:149], v241 offset:14336
    ds_read_b64_tr_b16 v[150:151], v241 offset:16128
    s_add_u32 m0, s13, 0
    s_nop 0
    buffer_load_dwordx4 v252, s[40:43], s71 offen lds
    ds_read_b64_tr_b16 v[152:153], v242 offset:14336
    ds_read_b64_tr_b16 v[154:155], v242 offset:16128
    ds_read_b64_tr_b16 v[156:157], v243 offset:14336
    ds_read_b64_tr_b16 v[158:159], v243 offset:16128
    s_waitcnt lgkmcnt(12)
    v_mfma_f32_16x16x32_bf16 v[192:195], v[128:131], v[120:123], v[192:195]
    v_mfma_f32_16x16x32_bf16 v[196:199], v[132:135], v[120:123], v[196:199]
    s_add_u32 m0, s13, 1024
    s_add_u32 s71, s71, s77
    buffer_load_dwordx4 v252, s[40:43], s71 offen lds
    s_waitcnt lgkmcnt(8)
    v_mfma_f32_16x16x32_bf16 v[200:203], v[136:139], v[120:123], v[200:203]
    v_mfma_f32_16x16x32_bf16 v[204:207], v[140:143], v[120:123], v[204:207]
    s_waitcnt lgkmcnt(4)
    v_mfma_f32_16x16x32_bf16 v[192:195], v[144:147], v[124:127], v[192:195]
    s_add_u32 m0, s13, 2048
    s_add_u32 s71, s71, s77
    buffer_load_dwordx4 v252, s[40:43], s71 offen lds
    v_mfma_f32_16x16x32_bf16 v[196:199], v[148:151], v[124:127], v[196:199]
    s_waitcnt lgkmcnt(0)
    v_mfma_f32_16x16x32_bf16 v[200:203], v[152:155], v[124:127], v[200:203]
    v_mfma_f32_16x16x32_bf16 v[204:207], v[156:159], v[124:127], v[204:207]
    s_add_u32 m0, s13, 3072
    s_add_u32 s71, s71, s77
    buffer_load_dwordx4 v252, s[40:43], s71 offen lds
    v_mov_b32 v5, 0x3e8b97f6
    v_pk_mul_f32 v[192:193], v[192:193], v[4:5] op_sel:[0,1] op_sel_hi:[1,1]
    v_pk_mul_f32 v[194:195], v[194:195], v[4:5] op_sel:[0,1] op_sel_hi:[1,1]
    v_cvt_pk_bf16_f32 v192, v192, v193
    v_cvt_pk_bf16_f32 v193, v194, v195
    ds_write_b64 v32, v[192:193]
    v_pk_mul_f32 v[196:197], v[196:197], v[4:5] op_sel:[0,1] op_sel_hi:[1,1]
    v_pk_mul_f32 v[198:199], v[198:199], v[4:5] op_sel:[0,1] op_sel_hi:[1,1]
    v_cvt_pk_bf16_f32 v196, v196, v197
    v_cvt_pk_bf16_f32 v197, v198, v199
    ds_write_b64 v33, v[196:197]
    v_pk_mul_f32 v[200:201], v[200:201], v[4:5] op_sel:[0,1] op_sel_hi:[1,1]
    v_pk_mul_f32 v[202:203], v[202:203], v[4:5] op_sel:[0,1] op_sel_hi:[1,1]
    v_cvt_pk_bf16_f32 v200, v200, v201
    v_cvt_pk_bf16_f32 v201, v202, v203
    ds_write_b64 v34, v[200:201]
    v_pk_mul_f32 v[204:205], v[204:205], v[4:5] op_sel:[0,1] op_sel_hi:[1,1]
    v_pk_mul_f32 v[206:207], v[206:207], v[4:5] op_sel:[0,1] op_sel_hi:[1,1]
    v_cvt_pk_bf16_f32 v204, v204, v205
    v_cvt_pk_bf16_f32 v205, v206, v207
    ds_write_b64 v35, v[204:205]
    v_mov_b32 v10, v67
    s_branch L_pg2
.p2align 12
L_pg2:
    s_waitcnt lgkmcnt(0)
    s_barrier
    ds_read_b128 v[48:51], v36 offset:0
    ds_read_b128 v[52:55], v36 offset:32
    ds_read_b128 v[56:59], v37 offset:0
    ds_read_b128 v[60:63], v37 offset:32
    ds_read_b128 v[64:67], v38 offset:0
    ds_read_b128 v[68:71], v38 offset:32
    ds_read_b128 v[72:75], v39 offset:0
    ds_read_b128 v[76:79], v39 offset:32
    s_waitcnt vmcnt(19)
    s_waitcnt lgkmcnt(6)
    s_mov_b32 exec_lo, 0
    v_mov_b64 v[54:55], 0
    s_mov_b32 exec_lo, -1
    v_mfma_f32_32x32x16_bf16 v[144:159], a[48:51], v[48:51], 0
    s_mul_i32 s53, s30, 7168
    s_mul_i32 s54, s94, 200704
    s_add_u32 s54, s54, s53
    s_add_u32 s69, s53, 49152
    s_lshr_b32 s96, s30, 1
    s_mul_i32 s96, s96, 7168
    v_mfma_f32_32x32x16_bf16 v[144:159], a[52:55], v[52:55], v[144:159]
    s_and_b32 s55, s30, 1
    s_lshl_b32 s55, s55, 12
    s_waitcnt lgkmcnt(4)
    s_mov_b32 exec_lo, 0
    v_mov_b64 v[62:63], 0
    s_mov_b32 exec_lo, -1
    v_mfma_f32_32x32x16_bf16 v[160:175], a[48:51], v[56:59], 0
    s_add_u32 s96, s96, s55
    s_add_u32 s96, s96, 135168
    s_cmp_eq_u32 s55, 0
    s_cselect_b32 s60, s96, 0x30000
    s_add_u32 s62, s54, 589824
    s_add_u32 s63, s54, 618496
    v_mfma_f32_32x32x16_bf16 v[160:175], a[52:55], v[60:63], v[160:175]
    v_max3_f32 v144, v144, v145, v146
    v_max3_f32 v144, v144, v147, v148
    v_max3_f32 v144, v144, v149, v150
    v_max3_f32 v144, v144, v151, v152
    v_max3_f32 v144, v144, v153, v154
    s_waitcnt lgkmcnt(2)
    s_mov_b32 exec_lo, 0
    v_mov_b64 v[70:71], 0
    s_mov_b32 exec_lo, -1
    v_mfma_f32_32x32x16_bf16 v[176:191], a[48:51], v[64:67], 0
    s_add_u32 s64, s54, 647168
    s_add_u32 s65, s54, 675840
    s_add_u32 s66, s54, 704512
    s_add_u32 s67, s54, 733184
    s_add_u32 s68, s54, 761856
    v_add_u32 v0, 4096, v4
    v_mfma_f32_32x32x16_bf16 v[176:191], a[52:55], v[68:71], v[176:191]
    v_max3_f32 v144, v144, v155, v156
    v_max3_f32 v144, v144, v157, v158
    v_max_f32 v144, v144, v159
    v_mov_b32 v145, v144
    s_nop 1
    v_permlane32_swap_b32 v144, v145
    v_max_f32 v144, v144, v145
    s_mov_b32 exec_lo, 0
    v_cvt_pk_bf16_f32 v54, -v144, 0
    s_mov_b32 exec_lo, -1
    s_waitcnt lgkmcnt(0)
    s_mov_b32 exec_lo, 0
    v_mov_b64 v[78:79], 0
    s_mov_b32 exec_lo, -1
    v_mfma_f32_32x32x16_bf16 v[192:207], a[48:51], v[72:75], 0
    s_lshr_b32 s55, s30, 1
    s_lshl_b32 s55, s55, 10
    s_xor_b32 s56, s55, 1024
    v_add_u32 v7, s55, v4
    v_mfma_f32_32x32x16_bf16 v[192:207], a[52:55], v[76:79], v[192:207]
    v_add_u32 v8, s56, v4
    s_lshl_b32 s52, s50, 4
    s_barrier
    s_waitcnt vmcnt(14)
    v_mfma_f32_32x32x16_bf16 v[16:31], a[0:3], v[48:51], 0
    v_mfma_f32_32x32x16_bf16 v[16:31], a[4:7], v[52:55], v[16:31]
    v_max3_f32 v160, v160, v161, v162
    v_max3_f32 v160, v160, v163, v164
    v_max3_f32 v160, v160, v165, v166
    v_max3_f32 v160, v160, v167, v168
    v_max3_f32 v160, v160, v169, v170
    v_max3_f32 v160, v160, v171, v172
    v_max3_f32 v160, v160, v173, v174
    v_max_f32 v160, v160, v175
    v_mov_b32 v161, v160
    s_nop 1
    v_permlane32_swap_b32 v160, v161
    v_max_f32 v160, v160, v161
    s_mov_b32 exec_lo, 0
    v_cvt_pk_bf16_f32 v62, -v160, 0
    s_mov_b32 exec_lo, -1
    s_lshl_b32 s53, s30, 2
    s_add_u32 s52, s52, s53
    v_mov_b32 v5, s52
    v_mov_b32 v6, s101
    v_cmp_eq_u32 vcc, 0, v1
    s_nop 1
    v_cndmask_b32 v11, v6, v5, vcc
    s_mul_i32 s57, s52, 7
    s_add_u32 s57, s57, 65536
    s_mul_i32 s98, s52, 3
    s_add_u32 s98, s98, 131072
    s_mov_b32 s36, s4
    s_mov_b32 s37, s5
    s_mov_b32 s38, 1835008
    v_mov_b32 v240, -1
    v_mov_b32 v241, -1
    v_mov_b32 v242, -1
    v_mov_b32 v243, -1
    s_mov_b32 s3, 0x07060302
    s_mov_b32 s74, 0
    s_cmp_eq_u32 s30, 0
    s_cselect_b32 s61, 6160384, s101
    v_exp_f32 v16, v16
    v_exp_f32 v17, v17
    v_exp_f32 v18, v18
    v_perm_b32 v16, v17, v16, s3
    v_exp_f32 v19, v19
    v_exp_f32 v20, v20
    v_perm_b32 v17, v19, v18, s3
    v_mfma_f32_32x32x16_bf16 v[32:47], a[0:3], v[56:59], 0
    v_exp_f32 v21, v21
    v_exp_f32 v22, v22
    v_perm_b32 v18, v21, v20, s3
    v_exp_f32 v23, v23
    v_mfma_f32_32x32x16_bf16 v[32:47], a[4:7], v[60:63], v[32:47]
    v_exp_f32 v24, v24
    v_perm_b32 v19, v23, v22, s3
    v_exp_f32 v25, v25
    v_exp_f32 v26, v26
    v_perm_b32 v20, v25, v24, s3
    v_exp_f32 v27, v27
    v_exp_f32 v28, v28
    v_perm_b32 v21, v27, v26, s3
    v_mfma_f32_32x32x16_bf16 a[208:223], a[8:11], v[16:19], 0
    v_exp_f32 v29, v29
    v_exp_f32 v30, v30
    v_perm_b32 v22, v29, v28, s3
    v_exp_f32 v31, v31
    v_exp_f32 v32, v32
    v_perm_b32 v23, v31, v30, s3
    v_exp_f32 v33, v33
    v_exp_f32 v34, v34
    v_mfma_f32_32x32x16_bf16 a[208:223], a[12:15], v[20:23], a[208:223]
    buffer_load_dword v9, v213, s[32:35], 0 offen sc1
    v_perm_b32 v32, v33, v32, s3
    v_exp_f32 v35, v35
    v_exp_f32 v36, v36
    v_perm_b32 v33, v35, v34, s3
    v_max3_f32 v176, v176, v177, v178
    v_max3_f32 v176, v176, v179, v180
    v_max3_f32 v176, v176, v181, v182
    v_max3_f32 v176, v176, v183, v184
    v_max3_f32 v176, v176, v185, v186
    v_max3_f32 v176, v176, v187, v188
    v_max3_f32 v176, v176, v189, v190
    v_max_f32 v176, v176, v191
    v_mov_b32 v177, v176
    s_nop 1
    v_permlane32_swap_b32 v176, v177
    v_max_f32 v176, v176, v177
    s_mov_b32 exec_lo, 0
    v_cvt_pk_bf16_f32 v70, -v176, 0
    s_mov_b32 exec_lo, -1
    v_mfma_f32_32x32x16_bf16 v[16:31], a[0:3], v[64:67], 0
    v_exp_f32 v37, v37
    v_exp_f32 v38, v38
    v_perm_b32 v34, v37, v36, s3
    v_exp_f32 v39, v39
    v_mfma_f32_32x32x16_bf16 v[16:31], a[4:7], v[68:71], v[16:31]
    v_exp_f32 v40, v40
    v_perm_b32 v35, v39, v38, s3
    v_exp_f32 v41, v41
    v_exp_f32 v42, v42
    v_perm_b32 v36, v41, v40, s3
    v_exp_f32 v43, v43
    v_exp_f32 v44, v44
    v_perm_b32 v37, v43, v42, s3
    v_mfma_f32_32x32x16_bf16 a[224:239], a[8:11], v[32:35], 0
    v_exp_f32 v45, v45
    v_exp_f32 v46, v46
    v_perm_b32 v38, v45, v44, s3
    v_exp_f32 v47, v47
    v_exp_f32 v16, v16
    v_perm_b32 v39, v47, v46, s3
    v_exp_f32 v17, v17
    v_exp_f32 v18, v18
    v_mfma_f32_32x32x16_bf16 a[224:239], a[12:15], v[36:39], a[224:239]
    v_perm_b32 v16, v17, v16, s3
    v_exp_f32 v19, v19
    v_exp_f32 v20, v20
    v_perm_b32 v17, v19, v18, s3
    v_max3_f32 v192, v192, v193, v194
    v_max3_f32 v192, v192, v195, v196
    v_max3_f32 v192, v192, v197, v198
    v_max3_f32 v192, v192, v199, v200
    v_max3_f32 v192, v192, v201, v202
    v_max3_f32 v192, v192, v203, v204
    v_max3_f32 v192, v192, v205, v206
    v_max_f32 v192, v192, v207
    v_mov_b32 v193, v192
    s_nop 1
    v_permlane32_swap_b32 v192, v193
    v_max_f32 v192, v192, v193
    s_mov_b32 exec_lo, 0
    v_cvt_pk_bf16_f32 v78, -v192, 0
    s_mov_b32 exec_lo, -1
    v_mfma_f32_32x32x16_bf16 v[32:47], a[0:3], v[72:75], 0
    v_exp_f32 v21, v21
    v_exp_f32 v22, v22
    v_perm_b32 v18, v21, v20, s3
    v_exp_f32 v23, v23
    v_mfma_f32_32x32x16_bf16 v[32:47], a[4:7], v[76:79], v[32:47]
    v_exp_f32 v24, v24
    v_perm_b32 v19, v23, v22, s3
    v_exp_f32 v25, v25
    v_exp_f32 v26, v26
    v_perm_b32 v20, v25, v24, s3
    v_exp_f32 v27, v27
    v_exp_f32 v28, v28
    v_perm_b32 v21, v27, v26, s3
    v_mfma_f32_32x32x16_bf16 a[240:255], a[8:11], v[16:19], 0
    v_exp_f32 v29, v29
    v_exp_f32 v30, v30
    v_perm_b32 v22, v29, v28, s3
    v_exp_f32 v31, v31
    v_exp_f32 v32, v32
    v_perm_b32 v23, v31, v30, s3
    v_exp_f32 v33, v33
    v_exp_f32 v34, v34
    v_mfma_f32_32x32x16_bf16 a[240:255], a[12:15], v[20:23], a[240:255]
    buffer_load_dwordx4 v[80:83], v4, s[32:35], s81 offen offset:0 sc1
    v_perm_b32 v32, v33, v32, s3
    v_exp_f32 v35, v35
    v_exp_f32 v36, v36
    v_perm_b32 v33, v35, v34, s3
    s_waitcnt vmcnt(12)
    v_mfma_f32_32x32x16_bf16 v[16:31], a[16:19], v[48:51], 0
    v_exp_f32 v37, v37
    v_exp_f32 v38, v38
    v_perm_b32 v34, v37, v36, s3
    v_exp_f32 v39, v39
    v_mfma_f32_32x32x16_bf16 v[16:31], a[20:23], v[52:55], v[16:31]
    buffer_load_dwordx4 v[84:87], v4, s[32:35], s81 offen offset:1024 sc1
    v_exp_f32 v40, v40
    v_perm_b32 v35, v39, v38, s3
    v_exp_f32 v41, v41
    v_exp_f32 v42, v42
    v_perm_b32 v36, v41, v40, s3
    v_exp_f32 v43, v43
    v_exp_f32 v44, v44
    v_perm_b32 v37, v43, v42, s3
    v_mfma_f32_32x32x16_bf16 v[128:143], a[8:11], v[32:35], 0
    v_exp_f32 v45, v45
    v_exp_f32 v46, v46
    v_perm_b32 v38, v45, v44, s3
    v_exp_f32 v47, v47
    v_exp_f32 v16, v16
    v_perm_b32 v39, v47, v46, s3
    v_exp_f32 v17, v17
    v_exp_f32 v18, v18
    v_mfma_f32_32x32x16_bf16 v[128:143], a[12:15], v[36:39], v[128:143]
    buffer_load_dwordx4 v[88:91], v4, s[32:35], s81 offen offset:2048 sc1
    v_perm_b32 v16, v17, v16, s3
    v_exp_f32 v19, v19
    v_exp_f32 v20, v20
    v_perm_b32 v17, v19, v18, s3
    v_mfma_f32_32x32x16_bf16 v[32:47], a[16:19], v[56:59], 0
    v_exp_f32 v21, v21
    v_exp_f32 v22, v22
    v_perm_b32 v18, v21, v20, s3
    v_exp_f32 v23, v23
    v_mfma_f32_32x32x16_bf16 v[32:47], a[20:23], v[60:63], v[32:47]
    buffer_load_dwordx4 v[92:95], v4, s[32:35], s81 offen offset:3072 sc1
    v_exp_f32 v24, v24
    v_perm_b32 v19, v23, v22, s3
    v_exp_f32 v25, v25
    v_exp_f32 v26, v26
    v_perm_b32 v20, v25, v24, s3
    v_exp_f32 v27, v27
    v_exp_f32 v28, v28
    v_perm_b32 v21, v27, v26, s3
    v_mfma_f32_32x32x16_bf16 a[208:223], a[24:27], v[16:19], a[208:223]
    v_exp_f32 v29, v29
    v_exp_f32 v30, v30
    v_perm_b32 v22, v29, v28, s3
    v_exp_f32 v31, v31
    v_exp_f32 v32, v32
    v_perm_b32 v23, v31, v30, s3
    v_exp_f32 v33, v33
    v_exp_f32 v34, v34
    v_mfma_f32_32x32x16_bf16 a[208:223], a[28:31], v[20:23], a[208:223]
    buffer_load_dwordx4 v[96:99], v4, s[32:35], s82 offen offset:0 sc1
    v_perm_b32 v32, v33, v32, s3
    v_exp_f32 v35, v35
    v_exp_f32 v36, v36
    v_perm_b32 v33, v35, v34, s3
    v_mfma_f32_32x32x16_bf16 v[16:31], a[16:19], v[64:67], 0
    v_exp_f32 v37, v37
    v_exp_f32 v38, v38
    v_perm_b32 v34, v37, v36, s3
    v_exp_f32 v39, v39
    v_mfma_f32_32x32x16_bf16 v[16:31], a[20:23], v[68:71], v[16:31]
    buffer_load_dwordx4 v[100:103], v4, s[32:35], s82 offen offset:1024 sc1
    v_exp_f32 v40, v40
    v_perm_b32 v35, v39, v38, s3
    v_exp_f32 v41, v41
    v_exp_f32 v42, v42
    v_perm_b32 v36, v41, v40, s3
    v_exp_f32 v43, v43
    v_exp_f32 v44, v44
    v_perm_b32 v37, v43, v42, s3
    v_mfma_f32_32x32x16_bf16 a[224:239], a[24:27], v[32:35], a[224:239]
    s_waitcnt vmcnt(6)
    v_cmp_ne_u32 vcc, s31, v9
    s_nop 1
    s_cbranch_vccnz L_slow2
L_back2:
    v_cmp_ne_u32 vcc, s100, v212
    s_nop 1
    s_cmp_eq_u64 vcc, 0
    s_cselect_b32 s100, -1, 0
    s_cmp_lg_u32 s100, 0
    s_cselect_b32 s54, s97, s101
    s_cselect_b32 s53, s70, s101
    s_cselect_b32 s55, 4325376, s101
    v_exp_f32 v45, v45
    v_exp_f32 v46, v46
    v_perm_b32 v38, v45, v44, s3
    v_exp_f32 v47, v47
    v_exp_f32 v16, v16
    v_perm_b32 v39, v47, v46, s3
    v_exp_f32 v17, v17
    v_exp_f32 v18, v18
    v_mfma_f32_32x32x16_bf16 a[224:239], a[28:31], v[36:39], a[224:239]
    buffer_load_dwordx4 v[104:107], v4, s[32:35], s82 offen offset:2048 sc1
    v_perm_b32 v16, v17, v16, s3
    v_exp_f32 v19, v19
    v_exp_f32 v20, v20
    v_perm_b32 v17, v19, v18, s3
    v_mfma_f32_32x32x16_bf16 v[32:47], a[16:19], v[72:75], 0
    v_exp_f32 v21, v21
    v_exp_f32 v22, v22
    v_perm_b32 v18, v21, v20, s3
    v_exp_f32 v23, v23
    v_mfma_f32_32x32x16_bf16 v[32:47], a[20:23], v[76:79], v[32:47]
    buffer_load_dwordx4 v[108:111], v4, s[32:35], s82 offen offset:3072 sc1
    v_exp_f32 v24, v24
    v_perm_b32 v19, v23, v22, s3
    v_exp_f32 v25, v25
    v_exp_f32 v26, v26
    v_perm_b32 v20, v25, v24, s3
    v_exp_f32 v27, v27
    v_exp_f32 v28, v28
    v_perm_b32 v21, v27, v26, s3
    v_mfma_f32_32x32x16_bf16 a[240:255], a[24:27], v[16:19], a[240:255]
    ds_read_b64_tr_b16 v[224:225], v244
    ds_read_b64_tr_b16 v[226:227], v245
    ds_read_b64_tr_b16 v[228:229], v246
    ds_read_b64_tr_b16 v[230:231], v247
    v_exp_f32 v29, v29
    v_exp_f32 v30, v30
    v_perm_b32 v22, v29, v28, s3
    v_exp_f32 v31, v31
    v_exp_f32 v32, v32
    v_perm_b32 v23, v31, v30, s3
    v_exp_f32 v33, v33
    v_exp_f32 v34, v34
    v_mfma_f32_32x32x16_bf16 a[240:255], a[28:31], v[20:23], a[240:255]
    buffer_load_dwordx4 v[112:115], v4, s[32:35], s83 offen offset:0 sc1
    v_perm_b32 v32, v33, v32, s3
    v_exp_f32 v35, v35
    v_exp_f32 v36, v36
    v_perm_b32 v33, v35, v34, s3
    v_mfma_f32_32x32x16_bf16 v[16:31], a[32:35], v[48:51], 0
    v_exp_f32 v37, v37
    v_exp_f32 v38, v38
    v_perm_b32 v34, v37, v36, s3
    v_exp_f32 v39, v39
    v_mfma_f32_32x32x16_bf16 v[16:31], a[36:39], v[52:55], v[16:31]
    buffer_load_dwordx4 v[116:119], v4, s[32:35], s83 offen offset:1024 sc1
    v_exp_f32 v40, v40
    v_perm_b32 v35, v39, v38, s3
    v_exp_f32 v41, v41
    v_exp_f32 v42, v42
    v_perm_b32 v36, v41, v40, s3
    v_exp_f32 v43, v43
    v_exp_f32 v44, v44
    v_perm_b32 v37, v43, v42, s3
    v_mfma_f32_32x32x16_bf16 v[128:143], a[24:27], v[32:35], v[128:143]
    ds_read_b64_tr_b16 v[232:233], v248
    ds_read_b64_tr_b16 v[234:235], v249
    ds_read_b64_tr_b16 v[236:237], v250
    ds_read_b64_tr_b16 v[238:239], v251
    v_exp_f32 v45, v45
    v_exp_f32 v46, v46
    v_perm_b32 v38, v45, v44, s3
    v_exp_f32 v47, v47
    v_exp_f32 v16, v16
    v_perm_b32 v39, v47, v46, s3
    v_exp_f32 v17, v17
    v_exp_f32 v18, v18
    v_mfma_f32_32x32x16_bf16 v[128:143], a[28:31], v[36:39], v[128:143]
    buffer_load_dwordx4 v[120:123], v4, s[32:35], s83 offen offset:2048 sc1
    v_perm_b32 v16, v17, v16, s3
    v_exp_f32 v19, v19
    v_exp_f32 v20, v20
    v_perm_b32 v17, v19, v18, s3
    v_mfma_f32_32x32x16_bf16 v[32:47], a[32:35], v[56:59], 0
    v_exp_f32 v21, v21
    v_exp_f32 v22, v22
    v_perm_b32 v18, v21, v20, s3
    v_exp_f32 v23, v23
    v_mfma_f32_32x32x16_bf16 v[32:47], a[36:39], v[60:63], v[32:47]
    buffer_load_dwordx4 v[124:127], v4, s[32:35], s83 offen offset:3072 sc1
    v_exp_f32 v24, v24
    v_perm_b32 v19, v23, v22, s3
    v_exp_f32 v25, v25
    v_exp_f32 v26, v26
    v_perm_b32 v20, v25, v24, s3
    v_exp_f32 v27, v27
    v_exp_f32 v28, v28
    v_perm_b32 v21, v27, v26, s3
    v_mfma_f32_32x32x16_bf16 a[208:223], a[40:43], v[16:19], a[208:223]
    s_waitcnt lgkmcnt(0)
    s_barrier
    buffer_store_dwordx4 v[224:227], v4, s[32:35], s76 offen offset:0 sc1
    v_exp_f32 v29, v29
    v_exp_f32 v30, v30
    v_perm_b32 v22, v29, v28, s3
    v_exp_f32 v31, v31
    v_exp_f32 v32, v32
    v_perm_b32 v23, v31, v30, s3
    v_exp_f32 v33, v33
    v_exp_f32 v34, v34
    v_mfma_f32_32x32x16_bf16 a[208:223], a[44:47], v[20:23], a[208:223]
    buffer_store_dwordx4 v[228:231], v4, s[32:35], s76 offen offset:1024 sc1
    v_perm_b32 v32, v33, v32, s3
    v_exp_f32 v35, v35
    v_exp_f32 v36, v36
    v_perm_b32 v33, v35, v34, s3
    v_mfma_f32_32x32x16_bf16 v[16:31], a[32:35], v[64:67], 0
    v_exp_f32 v37, v37
    v_exp_f32 v38, v38
    v_perm_b32 v34, v37, v36, s3
    v_exp_f32 v39, v39
    v_mfma_f32_32x32x16_bf16 v[16:31], a[36:39], v[68:71], v[16:31]
    buffer_load_dwordx4 a[108:111], v4, s[32:35], s62 offen offset:0 sc1
    v_exp_f32 v40, v40
    v_perm_b32 v35, v39, v38, s3
    v_exp_f32 v41, v41
    v_exp_f32 v42, v42
    v_perm_b32 v36, v41, v40, s3
    v_exp_f32 v43, v43
    v_exp_f32 v44, v44
    v_perm_b32 v37, v43, v42, s3
    v_mfma_f32_32x32x16_bf16 a[224:239], a[40:43], v[32:35], a[224:239]
    buffer_load_dwordx4 a[112:115], v4, s[32:35], s62 offen offset:1024 sc1
    v_exp_f32 v45, v45
    v_exp_f32 v46, v46
    v_perm_b32 v38, v45, v44, s3
    v_exp_f32 v47, v47
    v_exp_f32 v16, v16
    v_perm_b32 v39, v47, v46, s3
    v_exp_f32 v17, v17
    v_exp_f32 v18, v18
    v_mfma_f32_32x32x16_bf16 a[224:239], a[44:47], v[36:39], a[224:239]
    buffer_store_dwordx4 v[232:235], v4, s[32:35], s76 offen offset:2048 sc1
    v_perm_b32 v16, v17, v16, s3
    v_exp_f32 v19, v19
    v_exp_f32 v20, v20
    v_perm_b32 v17, v19, v18, s3
    v_mfma_f32_32x32x16_bf16 v[32:47], a[32:35], v[72:75], 0
    v_exp_f32 v21, v21
    v_exp_f32 v22, v22
    v_perm_b32 v18, v21, v20, s3
    v_exp_f32 v23, v23
    v_mfma_f32_32x32x16_bf16 v[32:47], a[36:39], v[76:79], v[32:47]
    buffer_load_dwordx4 a[116:119], v4, s[32:35], s62 offen offset:2048 sc1
    v_exp_f32 v24, v24
    v_perm_b32 v19, v23, v22, s3
    v_exp_f32 v25, v25
    v_exp_f32 v26, v26
    v_perm_b32 v20, v25, v24, s3
    v_exp_f32 v27, v27
    v_exp_f32 v28, v28
    v_perm_b32 v21, v27, v26, s3
    v_mfma_f32_32x32x16_bf16 a[240:255], a[40:43], v[16:19], a[240:255]
    buffer_load_dwordx4 a[120:123], v4, s[32:35], s62 offen offset:3072 sc1
    v_exp_f32 v29, v29
    v_exp_f32 v30, v30
    v_perm_b32 v22, v29, v28, s3
    v_exp_f32 v31, v31
    v_exp_f32 v32, v32
    v_perm_b32 v23, v31, v30, s3
    v_exp_f32 v33, v33
    v_exp_f32 v34, v34
    v_mfma_f32_32x32x16_bf16 a[240:255], a[44:47], v[20:23], a[240:255]
    buffer_store_dwordx4 v[236:239], v4, s[32:35], s76 offen offset:3072 sc1
    v_perm_b32 v32, v33, v32, s3
    v_exp_f32 v35, v35
    v_exp_f32 v36, v36
    v_perm_b32 v33, v35, v34, s3
    s_waitcnt vmcnt(16)
    v_mfma_f32_32x32x16_bf16 v[16:31], v[80:83], v[48:51], 0
    v_exp_f32 v37, v37
    v_exp_f32 v38, v38
    v_perm_b32 v34, v37, v36, s3
    v_exp_f32 v39, v39
    v_mfma_f32_32x32x16_bf16 v[16:31], v[84:87], v[52:55], v[16:31]
    buffer_load_dwordx4 a[124:127], v0, s[32:35], s62 offen offset:0 sc1
    v_exp_f32 v40, v40
    v_perm_b32 v35, v39, v38, s3
    v_exp_f32 v41, v41
    v_exp_f32 v42, v42
    v_perm_b32 v36, v41, v40, s3
    v_exp_f32 v43, v43
    v_exp_f32 v44, v44
    v_perm_b32 v37, v43, v42, s3
    v_mfma_f32_32x32x16_bf16 v[128:143], a[40:43], v[32:35], v[128:143]
    buffer_load_dwordx4 a[128:131], v0, s[32:35], s62 offen offset:1024 sc1
    v_exp_f32 v45, v45
    v_exp_f32 v46, v46
    v_perm_b32 v38, v45, v44, s3
    v_exp_f32 v47, v47
    v_exp_f32 v16, v16
    v_perm_b32 v39, v47, v46, s3
    v_exp_f32 v17, v17
    v_exp_f32 v18, v18
    v_mfma_f32_32x32x16_bf16 v[128:143], a[44:47], v[36:39], v[128:143]
    s_cmp_eq_u32 s100, 0
    s_cbranch_scc1 L_pois
L_poisb:
    buffer_store_dwordx4 v[240:243], v4, s[32:35], s53 offen offset:0
    v_perm_b32 v16, v17, v16, s3
    v_exp_f32 v19, v19
    v_exp_f32 v20, v20
    v_perm_b32 v17, v19, v18, s3
    v_mfma_f32_32x32x16_bf16 v[32:47], v[80:83], v[56:59], 0
    v_exp_f32 v21, v21
    v_exp_f32 v22, v22
    v_perm_b32 v18, v21, v20, s3
    v_exp_f32 v23, v23
    v_mfma_f32_32x32x16_bf16 v[32:47], v[84:87], v[60:63], v[32:47]
    buffer_load_dwordx4 a[132:135], v0, s[32:35], s62 offen offset:2048 sc1
    v_exp_f32 v24, v24
    v_perm_b32 v19, v23, v22, s3
    v_exp_f32 v25, v25
    v_exp_f32 v26, v26
    v_perm_b32 v20, v25, v24, s3
    v_exp_f32 v27, v27
    v_exp_f32 v28, v28
    v_perm_b32 v21, v27, v26, s3
    v_mfma_f32_32x32x16_bf16 a[208:223], v[88:91], v[16:19], a[208:223]
    v_exp_f32 v29, v29
    v_exp_f32 v30, v30
    v_perm_b32 v22, v29, v28, s3
    v_exp_f32 v31, v31
    v_exp_f32 v32, v32
    v_perm_b32 v23, v31, v30, s3
    v_exp_f32 v33, v33
    v_exp_f32 v34, v34
    v_mfma_f32_32x32x16_bf16 a[208:223], v[92:95], v[20:23], a[208:223]
    buffer_load_dwordx4 a[136:139], v4, s[32:35], s63 offen offset:0 sc1
    v_perm_b32 v32, v33, v32, s3
    v_exp_f32 v35, v35
    v_exp_f32 v36, v36
    v_perm_b32 v33, v35, v34, s3
    v_mfma_f32_32x32x16_bf16 v[16:31], v[80:83], v[64:67], 0
    v_exp_f32 v37, v37
    v_exp_f32 v38, v38
    v_perm_b32 v34, v37, v36, s3
    v_exp_f32 v39, v39
    v_mfma_f32_32x32x16_bf16 v[16:31], v[84:87], v[68:71], v[16:31]
    v_exp_f32 v40, v40
    v_perm_b32 v35, v39, v38, s3
    v_exp_f32 v41, v41
    v_exp_f32 v42, v42
    v_perm_b32 v36, v41, v40, s3
    v_exp_f32 v43, v43
    v_exp_f32 v44, v44
    v_perm_b32 v37, v43, v42, s3
    v_mfma_f32_32x32x16_bf16 a[224:239], v[88:91], v[32:35], a[224:239]
    v_exp_f32 v45, v45
    v_exp_f32 v46, v46
    v_perm_b32 v38, v45, v44, s3
    v_exp_f32 v47, v47
    v_exp_f32 v16, v16
    v_perm_b32 v39, v47, v46, s3
    v_exp_f32 v17, v17
    v_exp_f32 v18, v18
    v_mfma_f32_32x32x16_bf16 a[224:239], v[92:95], v[36:39], a[224:239]
    buffer_load_dwordx4 a[140:143], v4, s[32:35], s63 offen offset:1024 sc1
    v_perm_b32 v16, v17, v16, s3
    v_exp_f32 v19, v19
    v_exp_f32 v20, v20
    v_perm_b32 v17, v19, v18, s3
    v_mfma_f32_32x32x16_bf16 v[32:47], v[80:83], v[72:75], 0
    v_exp_f32 v21, v21
    v_exp_f32 v22, v22
    v_perm_b32 v18, v21, v20, s3
    v_exp_f32 v23, v23
    v_mfma_f32_32x32x16_bf16 v[32:47], v[84:87], v[76:79], v[32:47]
    v_exp_f32 v24, v24
    v_perm_b32 v19, v23, v22, s3
    v_exp_f32 v25, v25
    v_exp_f32 v26, v26
    v_perm_b32 v20, v25, v24, s3
    v_exp_f32 v27, v27
    v_exp_f32 v28, v28
    v_perm_b32 v21, v27, v26, s3
    v_mfma_f32_32x32x16_bf16 a[240:255], v[88:91], v[16:19], a[240:255]
    v_exp_f32 v29, v29
    v_exp_f32 v30, v30
    v_perm_b32 v22, v29, v28, s3
    v_exp_f32 v31, v31
    v_exp_f32 v32, v32
    v_perm_b32 v23, v31, v30, s3
    v_exp_f32 v33, v33
    v_exp_f32 v34, v34
    v_mfma_f32_32x32x16_bf16 a[240:255], v[92:95], v[20:23], a[240:255]
    s_waitcnt vmcnt(6)
    buffer_store_dword v12, v11, s[32:35], s57 offen sc1
    v_perm_b32 v32, v33, v32, s3
    v_exp_f32 v35, v35
    v_exp_f32 v36, v36
    v_perm_b32 v33, v35, v34, s3
    v_mfma_f32_32x32x16_bf16 v[16:31], v[96:99], v[48:51], 0
    v_exp_f32 v37, v37
    v_exp_f32 v38, v38
    v_perm_b32 v34, v37, v36, s3
    v_exp_f32 v39, v39
    v_mfma_f32_32x32x16_bf16 v[16:31], v[100:103], v[52:55], v[16:31]
    buffer_store_dwordx4 v[240:243], v4, s[32:35], s53 offen offset:1024
    v_exp_f32 v40, v40
    v_perm_b32 v35, v39, v38, s3
    v_exp_f32 v41, v41
    v_exp_f32 v42, v42
    v_perm_b32 v36, v41, v40, s3
    v_exp_f32 v43, v43
    v_exp_f32 v44, v44
    v_perm_b32 v37, v43, v42, s3
    v_mfma_f32_32x32x16_bf16 v[128:143], v[88:91], v[32:35], v[128:143]
    buffer_load_dwordx4 v[80:83], v4, s[32:35], s84 offen offset:0 sc1
    v_exp_f32 v45, v45
    v_exp_f32 v46, v46
    v_perm_b32 v38, v45, v44, s3
    v_exp_f32 v47, v47
    v_exp_f32 v16, v16
    v_perm_b32 v39, v47, v46, s3
    v_exp_f32 v17, v17
    v_exp_f32 v18, v18
    v_mfma_f32_32x32x16_bf16 v[128:143], v[92:95], v[36:39], v[128:143]
    buffer_load_dwordx4 v[84:87], v4, s[32:35], s84 offen offset:1024 sc1
    v_perm_b32 v16, v17, v16, s3
    v_exp_f32 v19, v19
    v_exp_f32 v20, v20
    v_perm_b32 v17, v19, v18, s3
    v_mfma_f32_32x32x16_bf16 v[32:47], v[96:99], v[56:59], 0
    v_exp_f32 v21, v21
    v_exp_f32 v22, v22
    v_perm_b32 v18, v21, v20, s3
    v_exp_f32 v23, v23
    v_mfma_f32_32x32x16_bf16 v[32:47], v[100:103], v[60:63], v[32:47]
    buffer_load_dwordx4 a[144:147], v4, s[32:35], s63 offen offset:2048 sc1
    v_exp_f32 v24, v24
    v_perm_b32 v19, v23, v22, s3
    v_exp_f32 v25, v25
    v_exp_f32 v26, v26
    v_perm_b32 v20, v25, v24, s3
    v_exp_f32 v27, v27
    v_exp_f32 v28, v28
    v_perm_b32 v21, v27, v26, s3
    v_mfma_f32_32x32x16_bf16 a[208:223], v[104:107], v[16:19], a[208:223]
    v_exp_f32 v29, v29
    v_exp_f32 v30, v30
    v_perm_b32 v22, v29, v28, s3
    v_exp_f32 v31, v31
    v_exp_f32 v32, v32
    v_perm_b32 v23, v31, v30, s3
    v_exp_f32 v33, v33
    v_exp_f32 v34, v34
    v_mfma_f32_32x32x16_bf16 a[208:223], v[108:111], v[20:23], a[208:223]
    buffer_load_dwordx4 v[88:91], v4, s[32:35], s84 offen offset:2048 sc1
    v_perm_b32 v32, v33, v32, s3
    v_exp_f32 v35, v35
    v_exp_f32 v36, v36
    v_perm_b32 v33, v35, v34, s3
    v_mfma_f32_32x32x16_bf16 v[16:31], v[96:99], v[64:67], 0
    v_exp_f32 v37, v37
    v_exp_f32 v38, v38
    v_perm_b32 v34, v37, v36, s3
    v_exp_f32 v39, v39
    v_mfma_f32_32x32x16_bf16 v[16:31], v[100:103], v[68:71], v[16:31]
    buffer_load_dwordx4 a[148:151], v4, s[32:35], s63 offen offset:3072 sc1
    v_exp_f32 v40, v40
    v_perm_b32 v35, v39, v38, s3
    v_exp_f32 v41, v41
    v_exp_f32 v42, v42
    v_perm_b32 v36, v41, v40, s3
    v_exp_f32 v43, v43
    v_exp_f32 v44, v44
    v_perm_b32 v37, v43, v42, s3
    v_mfma_f32_32x32x16_bf16 a[224:239], v[104:107], v[32:35], a[224:239]
    v_exp_f32 v45, v45
    v_exp_f32 v46, v46
    v_perm_b32 v38, v45, v44, s3
    v_exp_f32 v47, v47
    v_exp_f32 v16, v16
    v_perm_b32 v39, v47, v46, s3
    v_exp_f32 v17, v17
    v_exp_f32 v18, v18
    v_mfma_f32_32x32x16_bf16 a[224:239], v[108:111], v[36:39], a[224:239]
    buffer_store_dwordx4 v[240:243], v4, s[32:35], s54 offen offset:0
    v_perm_b32 v16, v17, v16, s3
    v_exp_f32 v19, v19
    v_exp_f32 v20, v20
    v_perm_b32 v17, v19, v18, s3
    v_mfma_f32_32x32x16_bf16 v[32:47], v[96:99], v[72:75], 0
    v_exp_f32 v21, v21
    v_exp_f32 v22, v22
    v_perm_b32 v18, v21, v20, s3
    v_exp_f32 v23, v23
    v_mfma_f32_32x32x16_bf16 v[32:47], v[100:103], v[76:79], v[32:47]
    buffer_load_dwordx4 v[92:95], v4, s[32:35], s84 offen offset:3072 sc1
    v_exp_f32 v24, v24
    v_perm_b32 v19, v23, v22, s3
    v_exp_f32 v25, v25
    v_exp_f32 v26, v26
    v_perm_b32 v20, v25, v24, s3
    v_exp_f32 v27, v27
    v_exp_f32 v28, v28
    v_perm_b32 v21, v27, v26, s3
    v_mfma_f32_32x32x16_bf16 a[240:255], v[104:107], v[16:19], a[240:255]
    buffer_load_dwordx4 a[152:155], v0, s[32:35], s63 offen offset:0 sc1
    v_exp_f32 v29, v29
    v_exp_f32 v30, v30
    v_perm_b32 v22, v29, v28, s3
    v_exp_f32 v31, v31
    v_exp_f32 v32, v32
    v_perm_b32 v23, v31, v30, s3
    v_exp_f32 v33, v33
    v_exp_f32 v34, v34
    v_mfma_f32_32x32x16_bf16 a[240:255], v[108:111], v[20:23], a[240:255]
    buffer_load_dwordx4 v[96:99], v4, s[32:35], s85 offen offset:0 sc1
    v_perm_b32 v32, v33, v32, s3
    v_exp_f32 v35, v35
    v_exp_f32 v36, v36
    v_perm_b32 v33, v35, v34, s3
    v_mfma_f32_32x32x16_bf16 v[16:31], v[112:115], v[48:51], 0
    v_exp_f32 v37, v37
    v_exp_f32 v38, v38
    v_perm_b32 v34, v37, v36, s3
    v_exp_f32 v39, v39
    v_mfma_f32_32x32x16_bf16 v[16:31], v[116:119], v[52:55], v[16:31]
    buffer_load_dwordx4 a[156:159], v0, s[32:35], s63 offen offset:1024 sc1
    v_exp_f32 v40, v40
    v_perm_b32 v35, v39, v38, s3
    v_exp_f32 v41, v41
    v_exp_f32 v42, v42
    v_perm_b32 v36, v41, v40, s3
    v_exp_f32 v43, v43
    v_exp_f32 v44, v44
    v_perm_b32 v37, v43, v42, s3
    v_mfma_f32_32x32x16_bf16 v[128:143], v[104:107], v[32:35], v[128:143]
    v_exp_f32 v45, v45
    v_exp_f32 v46, v46
    v_perm_b32 v38, v45, v44, s3
    v_exp_f32 v47, v47
    v_exp_f32 v16, v16
    v_perm_b32 v39, v47, v46, s3
    v_exp_f32 v17, v17
    v_exp_f32 v18, v18
    v_mfma_f32_32x32x16_bf16 v[128:143], v[108:111], v[36:39], v[128:143]
    buffer_load_dwordx4 v[100:103], v4, s[32:35], s85 offen offset:1024 sc1
    v_perm_b32 v16, v17, v16, s3
    v_exp_f32 v19, v19
    v_exp_f32 v20, v20
    v_perm_b32 v17, v19, v18, s3
    v_mfma_f32_32x32x16_bf16 v[32:47], v[112:115], v[56:59], 0
    v_exp_f32 v21, v21
    v_exp_f32 v22, v22
    v_perm_b32 v18, v21, v20, s3
    v_exp_f32 v23, v23
    v_mfma_f32_32x32x16_bf16 v[32:47], v[116:119], v[60:63], v[32:47]
    buffer_load_dwordx4 a[160:163], v0, s[32:35], s63 offen offset:2048 sc1
    v_exp_f32 v24, v24
    v_perm_b32 v19, v23, v22, s3
    v_exp_f32 v25, v25
    v_exp_f32 v26, v26
    v_perm_b32 v20, v25, v24, s3
    v_exp_f32 v27, v27
    v_exp_f32 v28, v28
    v_perm_b32 v21, v27, v26, s3
    v_mfma_f32_32x32x16_bf16 a[208:223], v[120:123], v[16:19], a[208:223]
    v_exp_f32 v29, v29
    v_exp_f32 v30, v30
    v_perm_b32 v22, v29, v28, s3
    v_exp_f32 v31, v31
    v_exp_f32 v32, v32
    v_perm_b32 v23, v31, v30, s3
    v_exp_f32 v33, v33
    v_exp_f32 v34, v34
    v_mfma_f32_32x32x16_bf16 a[208:223], v[124:127], v[20:23], a[208:223]
    buffer_store_dwordx4 v[240:243], v4, s[32:35], s54 offen offset:1024
    v_perm_b32 v32, v33, v32, s3
    v_exp_f32 v35, v35
    v_exp_f32 v36, v36
    v_perm_b32 v33, v35, v34, s3
    v_mfma_f32_32x32x16_bf16 v[16:31], v[112:115], v[64:67], 0
    v_exp_f32 v37, v37
    v_exp_f32 v38, v38
    v_perm_b32 v34, v37, v36, s3
    v_exp_f32 v39, v39
    v_mfma_f32_32x32x16_bf16 v[16:31], v[116:119], v[68:71], v[16:31]
    buffer_load_dwordx4 v[104:107], v4, s[32:35], s85 offen offset:2048 sc1
    v_exp_f32 v40, v40
    v_perm_b32 v35, v39, v38, s3
    v_exp_f32 v41, v41
    v_exp_f32 v42, v42
    v_perm_b32 v36, v41, v40, s3
    v_exp_f32 v43, v43
    v_exp_f32 v44, v44
    v_perm_b32 v37, v43, v42, s3
    v_mfma_f32_32x32x16_bf16 a[224:239], v[120:123], v[32:35], a[224:239]
    buffer_load_dwordx4 a[164:167], v4, s[32:35], s64 offen offset:0 sc1
    v_exp_f32 v45, v45
    v_exp_f32 v46, v46
    v_perm_b32 v38, v45, v44, s3
    v_exp_f32 v47, v47
    v_exp_f32 v16, v16
    v_perm_b32 v39, v47, v46, s3
    v_exp_f32 v17, v17
    v_exp_f32 v18, v18
    v_mfma_f32_32x32x16_bf16 a[224:239], v[124:127], v[36:39], a[224:239]
    buffer_load_dwordx4 v[108:111], v4, s[32:35], s85 offen offset:3072 sc1
    v_perm_b32 v16, v17, v16, s3
    v_exp_f32 v19, v19
    v_exp_f32 v20, v20
    v_perm_b32 v17, v19, v18, s3
    v_mfma_f32_32x32x16_bf16 v[32:47], v[112:115], v[72:75], 0
    v_exp_f32 v21, v21
    v_exp_f32 v22, v22
    v_perm_b32 v18, v21, v20, s3
    v_exp_f32 v23, v23
    v_mfma_f32_32x32x16_bf16 v[32:47], v[116:119], v[76:79], v[32:47]
    buffer_load_dwordx4 a[168:171], v4, s[32:35], s64 offen offset:1024 sc1
    v_exp_f32 v24, v24
    v_perm_b32 v19, v23, v22, s3
    v_exp_f32 v25, v25
    v_exp_f32 v26, v26
    v_perm_b32 v20, v25, v24, s3
    v_exp_f32 v27, v27
    v_exp_f32 v28, v28
    v_perm_b32 v21, v27, v26, s3
    v_mfma_f32_32x32x16_bf16 a[240:255], v[120:123], v[16:19], a[240:255]
    v_exp_f32 v29, v29
    v_exp_f32 v30, v30
    v_perm_b32 v22, v29, v28, s3
    v_exp_f32 v31, v31
    v_exp_f32 v32, v32
    v_perm_b32 v23, v31, v30, s3
    v_exp_f32 v33, v33
    v_exp_f32 v34, v34
    v_mfma_f32_32x32x16_bf16 a[240:255], v[124:127], v[20:23], a[240:255]
    buffer_load_dword v9, v218, s[32:35], 0 offen sc1
    v_perm_b32 v32, v33, v32, s3
    v_exp_f32 v35, v35
    v_exp_f32 v36, v36
    v_perm_b32 v33, v35, v34, s3
    s_waitcnt vmcnt(11)
    v_mfma_f32_32x32x16_bf16 v[16:31], v[80:83], v[48:51], 0
    v_exp_f32 v37, v37
    v_exp_f32 v38, v38
    v_perm_b32 v34, v37, v36, s3
    v_exp_f32 v39, v39
    v_mfma_f32_32x32x16_bf16 v[16:31], v[84:87], v[52:55], v[16:31]
    buffer_load_dwordx4 v[112:115], v4, s[32:35], s86 offen offset:0 sc1
    v_exp_f32 v40, v40
    v_perm_b32 v35, v39, v38, s3
    v_exp_f32 v41, v41
    v_exp_f32 v42, v42
    v_perm_b32 v36, v41, v40, s3
    v_exp_f32 v43, v43
    v_exp_f32 v44, v44
    v_perm_b32 v37, v43, v42, s3
    v_mfma_f32_32x32x16_bf16 v[128:143], v[120:123], v[32:35], v[128:143]
    buffer_load_dwordx4 a[172:175], v4, s[32:35], s64 offen offset:2048 sc1
    v_exp_f32 v45, v45
    v_exp_f32 v46, v46
    v_perm_b32 v38, v45, v44, s3
    v_exp_f32 v47, v47
    v_exp_f32 v16, v16
    v_perm_b32 v39, v47, v46, s3
    v_exp_f32 v17, v17
    v_exp_f32 v18, v18
    v_mfma_f32_32x32x16_bf16 v[128:143], v[124:127], v[36:39], v[128:143]
    buffer_store_dwordx4 v[240:243], v4, s[32:35], s54 offen offset:2048
    v_perm_b32 v16, v17, v16, s3
    v_exp_f32 v19, v19
    v_exp_f32 v20, v20
    v_perm_b32 v17, v19, v18, s3
    v_mfma_f32_32x32x16_bf16 v[32:47], v[80:83], v[56:59], 0
    v_exp_f32 v21, v21
    v_exp_f32 v22, v22
    v_perm_b32 v18, v21, v20, s3
    v_exp_f32 v23, v23
    v_mfma_f32_32x32x16_bf16 v[32:47], v[84:87], v[60:63], v[32:47]
    buffer_load_dwordx4 v[116:119], v4, s[32:35], s86 offen offset:1024 sc1
    v_exp_f32 v24, v24
    v_perm_b32 v19, v23, v22, s3
    v_exp_f32 v25, v25
    v_exp_f32 v26, v26
    v_perm_b32 v20, v25, v24, s3
    v_exp_f32 v27, v27
    v_exp_f32 v28, v28
    v_perm_b32 v21, v27, v26, s3
    v_mfma_f32_32x32x16_bf16 a[208:223], v[88:91], v[16:19], a[208:223]
    buffer_load_dwordx4 a[176:179], v4, s[32:35], s64 offen offset:3072 sc1
    v_exp_f32 v29, v29
    v_exp_f32 v30, v30
    v_perm_b32 v22, v29, v28, s3
    v_exp_f32 v31, v31
    v_exp_f32 v32, v32
    v_perm_b32 v23, v31, v30, s3
    v_exp_f32 v33, v33
    v_exp_f32 v34, v34
    v_mfma_f32_32x32x16_bf16 a[208:223], v[92:95], v[20:23], a[208:223]
    buffer_load_dwordx4 v[120:123], v4, s[32:35], s86 offen offset:2048 sc1
    v_perm_b32 v32, v33, v32, s3
    v_exp_f32 v35, v35
    v_exp_f32 v36, v36
    v_perm_b32 v33, v35, v34, s3
    v_mfma_f32_32x32x16_bf16 v[16:31], v[80:83], v[64:67], 0
    v_exp_f32 v37, v37
    v_exp_f32 v38, v38
    v_perm_b32 v34, v37, v36, s3
    v_exp_f32 v39, v39
    v_mfma_f32_32x32x16_bf16 v[16:31], v[84:87], v[68:71], v[16:31]
    buffer_load_dwordx4 a[180:183], v0, s[32:35], s64 offen offset:0 sc1
    v_exp_f32 v40, v40
    v_perm_b32 v35, v39, v38, s3
    v_exp_f32 v41, v41
    v_exp_f32 v42, v42
    v_perm_b32 v36, v41, v40, s3
    v_exp_f32 v43, v43
    v_exp_f32 v44, v44
    v_perm_b32 v37, v43, v42, s3
    v_mfma_f32_32x32x16_bf16 a[224:239], v[88:91], v[32:35], a[224:239]
    v_exp_f32 v45, v45
    v_exp_f32 v46, v46
    v_perm_b32 v38, v45, v44, s3
    v_exp_f32 v47, v47
    v_exp_f32 v16, v16
    v_perm_b32 v39, v47, v46, s3
    v_exp_f32 v17, v17
    v_exp_f32 v18, v18
    v_mfma_f32_32x32x16_bf16 a[224:239], v[92:95], v[36:39], a[224:239]
    s_waitcnt vmcnt(7)
    v_cmp_ne_u32 vcc, s31, v9
    s_nop 1
    s_cbranch_vccnz L_slow3
L_back3:
    v_perm_b32 v16, v17, v16, s3
    v_exp_f32 v19, v19
    v_exp_f32 v20, v20
    v_perm_b32 v17, v19, v18, s3
    v_mfma_f32_32x32x16_bf16 v[32:47], v[80:83], v[72:75], 0
    v_exp_f32 v21, v21
    v_exp_f32 v22, v22
    v_perm_b32 v18, v21, v20, s3
    v_exp_f32 v23, v23
    v_mfma_f32_32x32x16_bf16 v[32:47], v[84:87], v[76:79], v[32:47]
    buffer_load_dwordx4 v[124:127], v4, s[32:35], s86 offen offset:3072 sc1
    v_exp_f32 v24, v24
    v_perm_b32 v19, v23, v22, s3
    v_exp_f32 v25, v25
    v_exp_f32 v26, v26
    v_perm_b32 v20, v25, v24, s3
    v_exp_f32 v27, v27
    v_exp_f32 v28, v28
    v_perm_b32 v21, v27, v26, s3
    v_mfma_f32_32x32x16_bf16 a[240:255], v[88:91], v[16:19], a[240:255]
    buffer_load_dwordx4 a[184:187], v0, s[32:35], s64 offen offset:1024 sc1
    v_exp_f32 v29, v29
    v_exp_f32 v30, v30
    v_perm_b32 v22, v29, v28, s3
    v_exp_f32 v31, v31
    v_exp_f32 v32, v32
    v_perm_b32 v23, v31, v30, s3
    v_exp_f32 v33, v33
    v_exp_f32 v34, v34
    v_mfma_f32_32x32x16_bf16 a[240:255], v[92:95], v[20:23], a[240:255]
    buffer_store_dwordx4 v[240:243], v4, s[32:35], s54 offen offset:3072
    v_perm_b32 v32, v33, v32, s3
    v_exp_f32 v35, v35
    v_exp_f32 v36, v36
    v_perm_b32 v33, v35, v34, s3
    v_mfma_f32_32x32x16_bf16 v[16:31], v[96:99], v[48:51], 0
    v_exp_f32 v37, v37
    v_exp_f32 v38, v38
    v_perm_b32 v34, v37, v36, s3
    v_exp_f32 v39, v39
    v_mfma_f32_32x32x16_bf16 v[16:31], v[100:103], v[52:55], v[16:31]
    buffer_load_dwordx4 v[80:83], v4, s[32:35], s87 offen offset:0 sc1
    v_exp_f32 v40, v40
    v_perm_b32 v35, v39, v38, s3
    v_exp_f32 v41, v41
    v_exp_f32 v42, v42
    v_perm_b32 v36, v41, v40, s3
    v_exp_f32 v43, v43
    v_exp_f32 v44, v44
    v_perm_b32 v37, v43, v42, s3
    v_mfma_f32_32x32x16_bf16 v[128:143], v[88:91], v[32:35], v[128:143]
    s_add_u32 m0, s69, 0
    s_nop 0
    buffer_load_dwordx4 v4, s[32:35], s16 offen offset:0 sc1 lds
    v_exp_f32 v45, v45
    v_exp_f32 v46, v46
    v_perm_b32 v38, v45, v44, s3
    v_exp_f32 v47, v47
    v_exp_f32 v16, v16
    v_perm_b32 v39, v47, v46, s3
    v_exp_f32 v17, v17
    v_exp_f32 v18, v18
    v_mfma_f32_32x32x16_bf16 v[128:143], v[92:95], v[36:39], v[128:143]
    buffer_load_dwordx4 v[84:87], v4, s[32:35], s87 offen offset:1024 sc1
    v_perm_b32 v16, v17, v16, s3
    v_exp_f32 v19, v19
    v_exp_f32 v20, v20
    v_perm_b32 v17, v19, v18, s3
    v_mfma_f32_32x32x16_bf16 v[32:47], v[96:99], v[56:59], 0
    v_exp_f32 v21, v21
    v_exp_f32 v22, v22
    v_perm_b32 v18, v21, v20, s3
    v_exp_f32 v23, v23
    v_mfma_f32_32x32x16_bf16 v[32:47], v[100:103], v[60:63], v[32:47]
    buffer_load_dwordx4 a[188:191], v0, s[32:35], s64 offen offset:2048 sc1
    v_exp_f32 v24, v24
    v_perm_b32 v19, v23, v22, s3
    v_exp_f32 v25, v25
    v_exp_f32 v26, v26
    v_perm_b32 v20, v25, v24, s3
    v_exp_f32 v27, v27
    v_exp_f32 v28, v28
    v_perm_b32 v21, v27, v26, s3
    v_mfma_f32_32x32x16_bf16 a[208:223], v[104:107], v[16:19], a[208:223]
    buffer_load_dwordx4 v4, s[32:35], s16 offen offset:1024 sc1 lds
    v_exp_f32 v29, v29
    v_exp_f32 v30, v30
    v_perm_b32 v22, v29, v28, s3
    v_exp_f32 v31, v31
    v_exp_f32 v32, v32
    v_perm_b32 v23, v31, v30, s3
    v_exp_f32 v33, v33
    v_exp_f32 v34, v34
    v_mfma_f32_32x32x16_bf16 a[208:223], v[108:111], v[20:23], a[208:223]
    buffer_load_dwordx4 v[88:91], v4, s[32:35], s87 offen offset:2048 sc1
    v_perm_b32 v32, v33, v32, s3
    v_exp_f32 v35, v35
    v_exp_f32 v36, v36
    v_perm_b32 v33, v35, v34, s3
    v_mfma_f32_32x32x16_bf16 v[16:31], v[96:99], v[64:67], 0
    v_exp_f32 v37, v37
    v_exp_f32 v38, v38
    v_perm_b32 v34, v37, v36, s3
    v_exp_f32 v39, v39
    v_mfma_f32_32x32x16_bf16 v[16:31], v[100:103], v[68:71], v[16:31]
    buffer_load_dwordx4 a[192:195], v4, s[32:35], s65 offen offset:0 sc1
    v_exp_f32 v40, v40
    v_perm_b32 v35, v39, v38, s3
    v_exp_f32 v41, v41
    v_exp_f32 v42, v42
    v_perm_b32 v36, v41, v40, s3
    v_exp_f32 v43, v43
    v_exp_f32 v44, v44
    v_perm_b32 v37, v43, v42, s3
    v_mfma_f32_32x32x16_bf16 a[224:239], v[104:107], v[32:35], a[224:239]
    buffer_load_dwordx4 v4, s[32:35], s16 offen offset:2048 sc1 lds
    v_exp_f32 v45, v45
    v_exp_f32 v46, v46
    v_perm_b32 v38, v45, v44, s3
    v_exp_f32 v47, v47
    v_exp_f32 v16, v16
    v_perm_b32 v39, v47, v46, s3
    v_exp_f32 v17, v17
    v_exp_f32 v18, v18
    v_mfma_f32_32x32x16_bf16 a[224:239], v[108:111], v[36:39], a[224:239]
    buffer_store_dwordx4 v[240:243], v0, s[32:35], s54 offen offset:0
    v_perm_b32 v16, v17, v16, s3
    v_exp_f32 v19, v19
    v_exp_f32 v20, v20
    v_perm_b32 v17, v19, v18, s3
    v_mfma_f32_32x32x16_bf16 v[32:47], v[96:99], v[72:75], 0
    v_exp_f32 v21, v21
    v_exp_f32 v22, v22
    v_perm_b32 v18, v21, v20, s3
    v_exp_f32 v23, v23
    v_mfma_f32_32x32x16_bf16 v[32:47], v[100:103], v[76:79], v[32:47]
    buffer_load_dwordx4 v[92:95], v4, s[32:35], s87 offen offset:3072 sc1
    v_exp_f32 v24, v24
    v_perm_b32 v19, v23, v22, s3
    v_exp_f32 v25, v25
    v_exp_f32 v26, v26
    v_perm_b32 v20, v25, v24, s3
    v_exp_f32 v27, v27
    v_exp_f32 v28, v28
    v_perm_b32 v21, v27, v26, s3
    v_mfma_f32_32x32x16_bf16 a[240:255], v[104:107], v[16:19], a[240:255]
    buffer_load_dwordx4 a[196:199], v4, s[32:35], s65 offen offset:1024 sc1
    v_exp_f32 v29, v29
    v_exp_f32 v30, v30
    v_perm_b32 v22, v29, v28, s3
    v_exp_f32 v31, v31
    v_exp_f32 v32, v32
    v_perm_b32 v23, v31, v30, s3
    v_exp_f32 v33, v33
    v_exp_f32 v34, v34
    v_mfma_f32_32x32x16_bf16 a[240:255], v[108:111], v[20:23], a[240:255]
    buffer_load_dwordx4 v[96:99], v4, s[32:35], s88 offen offset:0 sc1
    v_perm_b32 v32, v33, v32, s3
    v_exp_f32 v35, v35
    v_exp_f32 v36, v36
    v_perm_b32 v33, v35, v34, s3
    s_waitcnt vmcnt(14)
    v_mfma_f32_32x32x16_bf16 v[16:31], v[112:115], v[48:51], 0
    v_exp_f32 v37, v37
    v_exp_f32 v38, v38
    v_perm_b32 v34, v37, v36, s3
    v_exp_f32 v39, v39
    v_mfma_f32_32x32x16_bf16 v[16:31], v[116:119], v[52:55], v[16:31]
    buffer_load_dwordx4 a[200:203], v4, s[32:35], s65 offen offset:2048 sc1
    v_exp_f32 v40, v40
    v_perm_b32 v35, v39, v38, s3
    v_exp_f32 v41, v41
    v_exp_f32 v42, v42
    v_perm_b32 v36, v41, v40, s3
    v_exp_f32 v43, v43
    v_exp_f32 v44, v44
    v_perm_b32 v37, v43, v42, s3
    v_mfma_f32_32x32x16_bf16 v[128:143], v[104:107], v[32:35], v[128:143]
    buffer_load_dwordx4 v4, s[32:35], s16 offen offset:3072 sc1 lds
    v_exp_f32 v45, v45
    v_exp_f32 v46, v46
    v_perm_b32 v38, v45, v44, s3
    v_exp_f32 v47, v47
    v_exp_f32 v16, v16
    v_perm_b32 v39, v47, v46, s3
    v_exp_f32 v17, v17
    v_exp_f32 v18, v18
    v_mfma_f32_32x32x16_bf16 v[128:143], v[108:111], v[36:39], v[128:143]
    buffer_load_dwordx4 v[100:103], v4, s[32:35], s88 offen offset:1024 sc1
    v_perm_b32 v16, v17, v16, s3
    v_exp_f32 v19, v19
    v_exp_f32 v20, v20
    v_perm_b32 v17, v19, v18, s3
    v_mfma_f32_32x32x16_bf16 v[32:47], v[112:115], v[56:59], 0
    v_exp_f32 v21, v21
    v_exp_f32 v22, v22
    v_perm_b32 v18, v21, v20, s3
    v_exp_f32 v23, v23
    v_mfma_f32_32x32x16_bf16 v[32:47], v[116:119], v[60:63], v[32:47]
    buffer_load_dwordx4 a[204:207], v4, s[32:35], s65 offen offset:3072 sc1
    v_exp_f32 v24, v24
    v_perm_b32 v19, v23, v22, s3
    v_exp_f32 v25, v25
    v_exp_f32 v26, v26
    v_perm_b32 v20, v25, v24, s3
    v_exp_f32 v27, v27
    v_exp_f32 v28, v28
    v_perm_b32 v21, v27, v26, s3
    v_mfma_f32_32x32x16_bf16 a[208:223], v[120:123], v[16:19], a[208:223]
    s_add_u32 m0, s69, 4096
    s_nop 0
    buffer_load_dwordx4 v0, s[32:35], s16 offen offset:0 sc1 lds
    v_exp_f32 v29, v29
    v_exp_f32 v30, v30
    v_perm_b32 v22, v29, v28, s3
    v_exp_f32 v31, v31
    v_exp_f32 v32, v32
    v_perm_b32 v23, v31, v30, s3
    v_exp_f32 v33, v33
    v_exp_f32 v34, v34
    v_mfma_f32_32x32x16_bf16 a[208:223], v[124:127], v[20:23], a[208:223]
    buffer_store_dwordx4 v[240:243], v0, s[32:35], s54 offen offset:1024
    v_perm_b32 v32, v33, v32, s3
    v_exp_f32 v35, v35
    v_exp_f32 v36, v36
    v_perm_b32 v33, v35, v34, s3
    v_mfma_f32_32x32x16_bf16 v[16:31], v[112:115], v[64:67], 0
    v_exp_f32 v37, v37
    v_exp_f32 v38, v38
    v_perm_b32 v34, v37, v36, s3
    v_exp_f32 v39, v39
    v_mfma_f32_32x32x16_bf16 v[16:31], v[116:119], v[68:71], v[16:31]
    buffer_load_dwordx4 v[104:107], v4, s[32:35], s88 offen offset:2048 sc1
    v_exp_f32 v40, v40
    v_perm_b32 v35, v39, v38, s3
    v_exp_f32 v41, v41
    v_exp_f32 v42, v42
    v_perm_b32 v36, v41, v40, s3
    v_exp_f32 v43, v43
    v_exp_f32 v44, v44
    v_perm_b32 v37, v43, v42, s3
    v_mfma_f32_32x32x16_bf16 a[224:239], v[120:123], v[32:35], a[224:239]
    buffer_load_dwordx4 v[144:147], v0, s[32:35], s65 offen offset:0 sc1
    v_exp_f32 v45, v45
    v_exp_f32 v46, v46
    v_perm_b32 v38, v45, v44, s3
    v_exp_f32 v47, v47
    v_exp_f32 v16, v16
    v_perm_b32 v39, v47, v46, s3
    v_exp_f32 v17, v17
    v_exp_f32 v18, v18
    v_mfma_f32_32x32x16_bf16 a[224:239], v[124:127], v[36:39], a[224:239]
    buffer_load_dwordx4 v[108:111], v4, s[32:35], s88 offen offset:3072 sc1
    v_perm_b32 v16, v17, v16, s3
    v_exp_f32 v19, v19
    v_exp_f32 v20, v20
    v_perm_b32 v17, v19, v18, s3
    v_mfma_f32_32x32x16_bf16 v[32:47], v[112:115], v[72:75], 0
    v_exp_f32 v21, v21
    v_exp_f32 v22, v22
    v_perm_b32 v18, v21, v20, s3
    v_exp_f32 v23, v23
    v_mfma_f32_32x32x16_bf16 v[32:47], v[116:119], v[76:79], v[32:47]
    buffer_load_dwordx4 v[148:151], v0, s[32:35], s65 offen offset:1024 sc1
    v_exp_f32 v24, v24
    v_perm_b32 v19, v23, v22, s3
    v_exp_f32 v25, v25
    v_exp_f32 v26, v26
    v_perm_b32 v20, v25, v24, s3
    v_exp_f32 v27, v27
    v_exp_f32 v28, v28
    v_perm_b32 v21, v27, v26, s3
    v_mfma_f32_32x32x16_bf16 a[240:255], v[120:123], v[16:19], a[240:255]
    buffer_load_dwordx4 v0, s[32:35], s16 offen offset:1024 sc1 lds
    v_exp_f32 v29, v29
    v_exp_f32 v30, v30
    v_perm_b32 v22, v29, v28, s3
    v_exp_f32 v31, v31
    v_exp_f32 v32, v32
    v_perm_b32 v23, v31, v30, s3
    v_exp_f32 v33, v33
    v_exp_f32 v34, v34
    v_mfma_f32_32x32x16_bf16 a[240:255], v[124:127], v[20:23], a[240:255]
    buffer_load_dwordx4 v[112:115], v4, s[32:35], s89 offen offset:0 sc1
    v_perm_b32 v32, v33, v32, s3
    v_exp_f32 v35, v35
    v_exp_f32 v36, v36
    v_perm_b32 v33, v35, v34, s3
    s_waitcnt vmcnt(14)
    v_mfma_f32_32x32x16_bf16 v[16:31], v[80:83], v[48:51], 0
    v_exp_f32 v37, v37
    v_exp_f32 v38, v38
    v_perm_b32 v34, v37, v36, s3
    v_exp_f32 v39, v39
    v_mfma_f32_32x32x16_bf16 v[16:31], v[84:87], v[52:55], v[16:31]
    buffer_load_dwordx4 v[152:155], v0, s[32:35], s65 offen offset:2048 sc1
    v_exp_f32 v40, v40
    v_perm_b32 v35, v39, v38, s3
    v_exp_f32 v41, v41
    v_exp_f32 v42, v42
    v_perm_b32 v36, v41, v40, s3
    v_exp_f32 v43, v43
    v_exp_f32 v44, v44
    v_perm_b32 v37, v43, v42, s3
    v_mfma_f32_32x32x16_bf16 v[128:143], v[120:123], v[32:35], v[128:143]
    buffer_load_dwordx4 v0, s[32:35], s16 offen offset:2048 sc1 lds
    v_exp_f32 v45, v45
    v_exp_f32 v46, v46
    v_perm_b32 v38, v45, v44, s3
    v_exp_f32 v47, v47
    v_exp_f32 v16, v16
    v_perm_b32 v39, v47, v46, s3
    v_exp_f32 v17, v17
    v_exp_f32 v18, v18
    v_mfma_f32_32x32x16_bf16 v[128:143], v[124:127], v[36:39], v[128:143]
    buffer_store_dwordx4 v[240:243], v0, s[32:35], s54 offen offset:2048
    v_perm_b32 v16, v17, v16, s3
    v_exp_f32 v19, v19
    v_exp_f32 v20, v20
    v_perm_b32 v17, v19, v18, s3
    v_mfma_f32_32x32x16_bf16 v[32:47], v[80:83], v[56:59], 0
    v_exp_f32 v21, v21
    v_exp_f32 v22, v22
    v_perm_b32 v18, v21, v20, s3
    v_exp_f32 v23, v23
    v_mfma_f32_32x32x16_bf16 v[32:47], v[84:87], v[60:63], v[32:47]
    buffer_load_dwordx4 v[116:119], v4, s[32:35], s89 offen offset:1024 sc1
    v_exp_f32 v24, v24
    v_perm_b32 v19, v23, v22, s3
    v_exp_f32 v25, v25
    v_exp_f32 v26, v26
    v_perm_b32 v20, v25, v24, s3
    v_exp_f32 v27, v27
    v_exp_f32 v28, v28
    v_perm_b32 v21, v27, v26, s3
    v_mfma_f32_32x32x16_bf16 a[208:223], v[88:91], v[16:19], a[208:223]
    buffer_load_dwordx4 v[156:159], v4, s[32:35], s66 offen offset:0 sc1
    v_exp_f32 v29, v29
    v_exp_f32 v30, v30
    v_perm_b32 v22, v29, v28, s3
    v_exp_f32 v31, v31
    v_exp_f32 v32, v32
    v_perm_b32 v23, v31, v30, s3
    v_exp_f32 v33, v33
    v_exp_f32 v34, v34
    v_mfma_f32_32x32x16_bf16 a[208:223], v[92:95], v[20:23], a[208:223]
    buffer_load_dwordx4 v[120:123], v4, s[32:35], s89 offen offset:2048 sc1
    v_perm_b32 v32, v33, v32, s3
    v_exp_f32 v35, v35
    v_exp_f32 v36, v36
    v_perm_b32 v33, v35, v34, s3
    v_mfma_f32_32x32x16_bf16 v[16:31], v[80:83], v[64:67], 0
    v_exp_f32 v37, v37
    v_exp_f32 v38, v38
    v_perm_b32 v34, v37, v36, s3
    v_exp_f32 v39, v39
    v_mfma_f32_32x32x16_bf16 v[16:31], v[84:87], v[68:71], v[16:31]
    buffer_load_dwordx4 v[160:163], v4, s[32:35], s66 offen offset:1024 sc1
    v_exp_f32 v40, v40
    v_perm_b32 v35, v39, v38, s3
    v_exp_f32 v41, v41
    v_exp_f32 v42, v42
    v_perm_b32 v36, v41, v40, s3
    v_exp_f32 v43, v43
    v_exp_f32 v44, v44
    v_perm_b32 v37, v43, v42, s3
    v_mfma_f32_32x32x16_bf16 a[224:239], v[88:91], v[32:35], a[224:239]
    s_add_u32 m0, s69, 28672
    s_nop 0
    buffer_load_dwordx4 v4, s[32:35], s17 offen offset:0 sc1 lds
    v_exp_f32 v45, v45
    v_exp_f32 v46, v46
    v_perm_b32 v38, v45, v44, s3
    v_exp_f32 v47, v47
    v_exp_f32 v16, v16
    v_perm_b32 v39, v47, v46, s3
    v_exp_f32 v17, v17
    v_exp_f32 v18, v18
    v_mfma_f32_32x32x16_bf16 a[224:239], v[92:95], v[36:39], a[224:239]
    buffer_load_dwordx4 v[124:127], v4, s[32:35], s89 offen offset:3072 sc1
    v_perm_b32 v16, v17, v16, s3
    v_exp_f32 v19, v19
    v_exp_f32 v20, v20
    v_perm_b32 v17, v19, v18, s3
    v_mfma_f32_32x32x16_bf16 v[32:47], v[80:83], v[72:75], 0
    v_exp_f32 v21, v21
    v_exp_f32 v22, v22
    v_perm_b32 v18, v21, v20, s3
    v_exp_f32 v23, v23
    v_mfma_f32_32x32x16_bf16 v[32:47], v[84:87], v[76:79], v[32:47]
    buffer_load_dwordx4 v4, s[32:35], s17 offen offset:1024 sc1 lds
    v_exp_f32 v24, v24
    v_perm_b32 v19, v23, v22, s3
    v_exp_f32 v25, v25
    v_exp_f32 v26, v26
    v_perm_b32 v20, v25, v24, s3
    v_exp_f32 v27, v27
    v_exp_f32 v28, v28
    v_perm_b32 v21, v27, v26, s3
    v_mfma_f32_32x32x16_bf16 a[240:255], v[88:91], v[16:19], a[240:255]
    buffer_load_dwordx4 v4, s[32:35], s17 offen offset:2048 sc1 lds
    v_exp_f32 v29, v29
    v_exp_f32 v30, v30
    v_perm_b32 v22, v29, v28, s3
    v_exp_f32 v31, v31
    v_exp_f32 v32, v32
    v_perm_b32 v23, v31, v30, s3
    v_exp_f32 v33, v33
    v_exp_f32 v34, v34
    v_mfma_f32_32x32x16_bf16 a[240:255], v[92:95], v[20:23], a[240:255]
    buffer_store_dwordx4 v[240:243], v216, s[32:35], s55 offen offset:0
    v_perm_b32 v32, v33, v32, s3
    v_exp_f32 v35, v35
    v_exp_f32 v36, v36
    v_perm_b32 v33, v35, v34, s3
    s_waitcnt vmcnt(15)
    v_mfma_f32_32x32x16_bf16 v[16:31], v[96:99], v[48:51], 0
    v_exp_f32 v37, v37
    v_exp_f32 v38, v38
    v_perm_b32 v34, v37, v36, s3
    v_exp_f32 v39, v39
    v_mfma_f32_32x32x16_bf16 v[16:31], v[100:103], v[52:55], v[16:31]
    buffer_load_dwordx4 v[80:83], v4, s[32:35], s90 offen offset:0 sc1
    v_exp_f32 v40, v40
    v_perm_b32 v35, v39, v38, s3
    v_exp_f32 v41, v41
    v_exp_f32 v42, v42
    v_perm_b32 v36, v41, v40, s3
    v_exp_f32 v43, v43
    v_exp_f32 v44, v44
    v_perm_b32 v37, v43, v42, s3
    v_mfma_f32_32x32x16_bf16 v[128:143], v[88:91], v[32:35], v[128:143]
    buffer_load_dwordx4 v[164:167], v4, s[32:35], s66 offen offset:2048 sc1
    v_exp_f32 v45, v45
    v_exp_f32 v46, v46
    v_perm_b32 v38, v45, v44, s3
    v_exp_f32 v47, v47
    v_exp_f32 v16, v16
    v_perm_b32 v39, v47, v46, s3
    v_exp_f32 v17, v17
    v_exp_f32 v18, v18
    v_mfma_f32_32x32x16_bf16 v[128:143], v[92:95], v[36:39], v[128:143]
    buffer_load_dwordx4 v[84:87], v4, s[32:35], s90 offen offset:1024 sc1
    v_perm_b32 v16, v17, v16, s3
    v_exp_f32 v19, v19
    v_exp_f32 v20, v20
    v_perm_b32 v17, v19, v18, s3
    v_mfma_f32_32x32x16_bf16 v[32:47], v[96:99], v[56:59], 0
    v_exp_f32 v21, v21
    v_exp_f32 v22, v22
    v_perm_b32 v18, v21, v20, s3
    v_exp_f32 v23, v23
    v_mfma_f32_32x32x16_bf16 v[32:47], v[100:103], v[60:63], v[32:47]
    buffer_load_dwordx4 v[168:171], v4, s[32:35], s66 offen offset:3072 sc1
    v_exp_f32 v24, v24
    v_perm_b32 v19, v23, v22, s3
    v_exp_f32 v25, v25
    v_exp_f32 v26, v26
    v_perm_b32 v20, v25, v24, s3
    v_exp_f32 v27, v27
    v_exp_f32 v28, v28
    v_perm_b32 v21, v27, v26, s3
    v_mfma_f32_32x32x16_bf16 a[208:223], v[104:107], v[16:19], a[208:223]
    buffer_load_dwordx4 v4, s[32:35], s17 offen offset:3072 sc1 lds
    v_exp_f32 v29, v29
    v_exp_f32 v30, v30
    v_perm_b32 v22, v29, v28, s3
    v_exp_f32 v31, v31
    v_exp_f32 v32, v32
    v_perm_b32 v23, v31, v30, s3
    v_exp_f32 v33, v33
    v_exp_f32 v34, v34
    v_mfma_f32_32x32x16_bf16 a[208:223], v[108:111], v[20:23], a[208:223]
    buffer_load_dwordx4 v[88:91], v4, s[32:35], s90 offen offset:2048 sc1
    v_perm_b32 v32, v33, v32, s3
    v_exp_f32 v35, v35
    v_exp_f32 v36, v36
    v_perm_b32 v33, v35, v34, s3
    v_mfma_f32_32x32x16_bf16 v[16:31], v[96:99], v[64:67], 0
    v_exp_f32 v37, v37
    v_exp_f32 v38, v38
    v_perm_b32 v34, v37, v36, s3
    v_exp_f32 v39, v39
    v_mfma_f32_32x32x16_bf16 v[16:31], v[100:103], v[68:71], v[16:31]
    buffer_load_dwordx4 v[172:175], v0, s[32:35], s66 offen offset:0 sc1
    v_exp_f32 v40, v40
    v_perm_b32 v35, v39, v38, s3
    v_exp_f32 v41, v41
    v_exp_f32 v42, v42
    v_perm_b32 v36, v41, v40, s3
    v_exp_f32 v43, v43
    v_exp_f32 v44, v44
    v_perm_b32 v37, v43, v42, s3
    v_mfma_f32_32x32x16_bf16 a[224:239], v[104:107], v[32:35], a[224:239]
    s_add_u32 m0, s69, 32768
    s_nop 0
    buffer_load_dwordx4 v0, s[32:35], s17 offen offset:0 sc1 lds
    v_exp_f32 v45, v45
    v_exp_f32 v46, v46
    v_perm_b32 v38, v45, v44, s3
    v_exp_f32 v47, v47
    v_exp_f32 v16, v16
    v_perm_b32 v39, v47, v46, s3
    v_exp_f32 v17, v17
    v_exp_f32 v18, v18
    v_mfma_f32_32x32x16_bf16 a[224:239], v[108:111], v[36:39], a[224:239]
    buffer_store_dwordx4 v[240:243], v217, s[32:35], s55 offen offset:2048
    v_perm_b32 v16, v17, v16, s3
    v_exp_f32 v19, v19
    v_exp_f32 v20, v20
    v_perm_b32 v17, v19, v18, s3
    v_mfma_f32_32x32x16_bf16 v[32:47], v[96:99], v[72:75], 0
    v_exp_f32 v21, v21
    v_exp_f32 v22, v22
    v_perm_b32 v18, v21, v20, s3
    v_exp_f32 v23, v23
    v_mfma_f32_32x32x16_bf16 v[32:47], v[100:103], v[76:79], v[32:47]
    buffer_load_dwordx4 v[92:95], v4, s[32:35], s90 offen offset:3072 sc1
    v_exp_f32 v24, v24
    v_perm_b32 v19, v23, v22, s3
    v_exp_f32 v25, v25
    v_exp_f32 v26, v26
    v_perm_b32 v20, v25, v24, s3
    v_exp_f32 v27, v27
    v_exp_f32 v28, v28
    v_perm_b32 v21, v27, v26, s3
    v_mfma_f32_32x32x16_bf16 a[240:255], v[104:107], v[16:19], a[240:255]
    buffer_load_dwordx4 v[176:179], v0, s[32:35], s66 offen offset:1024 sc1
    v_exp_f32 v29, v29
    v_exp_f32 v30, v30
    v_perm_b32 v22, v29, v28, s3
    v_exp_f32 v31, v31
    v_exp_f32 v32, v32
    v_perm_b32 v23, v31, v30, s3
    v_exp_f32 v33, v33
    v_exp_f32 v34, v34
    v_mfma_f32_32x32x16_bf16 a[240:255], v[108:111], v[20:23], a[240:255]
    buffer_load_dwordx4 v[96:99], v4, s[32:35], s91 offen offset:0 sc1
    v_perm_b32 v32, v33, v32, s3
    v_exp_f32 v35, v35
    v_exp_f32 v36, v36
    v_perm_b32 v33, v35, v34, s3
    s_waitcnt vmcnt(15)
    v_mfma_f32_32x32x16_bf16 v[16:31], v[112:115], v[48:51], 0
    v_exp_f32 v37, v37
    v_exp_f32 v38, v38
    v_perm_b32 v34, v37, v36, s3
    v_exp_f32 v39, v39
    v_mfma_f32_32x32x16_bf16 v[16:31], v[116:119], v[52:55], v[16:31]
    buffer_load_dwordx4 v[180:183], v0, s[32:35], s66 offen offset:2048 sc1
    v_exp_f32 v40, v40
    v_perm_b32 v35, v39, v38, s3
    v_exp_f32 v41, v41
    v_exp_f32 v42, v42
    v_perm_b32 v36, v41, v40, s3
    v_exp_f32 v43, v43
    v_exp_f32 v44, v44
    v_perm_b32 v37, v43, v42, s3
    v_mfma_f32_32x32x16_bf16 v[128:143], v[104:107], v[32:35], v[128:143]
    buffer_load_dwordx4 v0, s[32:35], s17 offen offset:1024 sc1 lds
    v_exp_f32 v45, v45
    v_exp_f32 v46, v46
    v_perm_b32 v38, v45, v44, s3
    v_exp_f32 v47, v47
    v_exp_f32 v16, v16
    v_perm_b32 v39, v47, v46, s3
    v_exp_f32 v17, v17
    v_exp_f32 v18, v18
    v_mfma_f32_32x32x16_bf16 v[128:143], v[108:111], v[36:39], v[128:143]
    buffer_load_dwordx4 v[100:103], v4, s[32:35], s91 offen offset:1024 sc1
    v_perm_b32 v16, v17, v16, s3
    v_exp_f32 v19, v19
    v_exp_f32 v20, v20
    v_perm_b32 v17, v19, v18, s3
    v_mfma_f32_32x32x16_bf16 v[32:47], v[112:115], v[56:59], 0
    v_exp_f32 v21, v21
    v_exp_f32 v22, v22
    v_perm_b32 v18, v21, v20, s3
    v_exp_f32 v23, v23
    v_mfma_f32_32x32x16_bf16 v[32:47], v[116:119], v[60:63], v[32:47]
    buffer_load_dwordx4 v[184:187], v4, s[32:35], s67 offen offset:0 sc1
    v_exp_f32 v24, v24
    v_perm_b32 v19, v23, v22, s3
    v_exp_f32 v25, v25
    v_exp_f32 v26, v26
    v_perm_b32 v20, v25, v24, s3
    v_exp_f32 v27, v27
    v_exp_f32 v28, v28
    v_perm_b32 v21, v27, v26, s3
    v_mfma_f32_32x32x16_bf16 a[208:223], v[120:123], v[16:19], a[208:223]
    buffer_load_dwordx4 v0, s[32:35], s17 offen offset:2048 sc1 lds
    v_exp_f32 v29, v29
    v_exp_f32 v30, v30
    v_perm_b32 v22, v29, v28, s3
    v_exp_f32 v31, v31
    v_exp_f32 v32, v32
    v_perm_b32 v23, v31, v30, s3
    v_exp_f32 v33, v33
    v_exp_f32 v34, v34
    v_mfma_f32_32x32x16_bf16 a[208:223], v[124:127], v[20:23], a[208:223]
    s_mov_b64 exec, 0xff
    buffer_store_dwordx2 v[240:241], v216, s[32:35], s61 offen sc1
    s_mov_b64 exec, -1
    v_perm_b32 v32, v33, v32, s3
    v_exp_f32 v35, v35
    v_exp_f32 v36, v36
    v_perm_b32 v33, v35, v34, s3
    v_mfma_f32_32x32x16_bf16 v[16:31], v[112:115], v[64:67], 0
    v_exp_f32 v37, v37
    v_exp_f32 v38, v38
    v_perm_b32 v34, v37, v36, s3
    v_exp_f32 v39, v39
    v_mfma_f32_32x32x16_bf16 v[16:31], v[116:119], v[68:71], v[16:31]
    buffer_load_dwordx4 v[104:107], v4, s[32:35], s91 offen offset:2048 sc1
    v_exp_f32 v40, v40
    v_perm_b32 v35, v39, v38, s3
    v_exp_f32 v41, v41
    v_exp_f32 v42, v42
    v_perm_b32 v36, v41, v40, s3
    v_exp_f32 v43, v43
    v_exp_f32 v44, v44
    v_perm_b32 v37, v43, v42, s3
    v_mfma_f32_32x32x16_bf16 a[224:239], v[120:123], v[32:35], a[224:239]
    buffer_load_dwordx4 v[188:191], v4, s[32:35], s67 offen offset:1024 sc1
    v_exp_f32 v45, v45
    v_exp_f32 v46, v46
    v_perm_b32 v38, v45, v44, s3
    v_exp_f32 v47, v47
    v_exp_f32 v16, v16
    v_perm_b32 v39, v47, v46, s3
    v_exp_f32 v17, v17
    v_exp_f32 v18, v18
    v_mfma_f32_32x32x16_bf16 a[224:239], v[124:127], v[36:39], a[224:239]
    buffer_load_dwordx4 v[108:111], v4, s[32:35], s91 offen offset:3072 sc1
    v_perm_b32 v16, v17, v16, s3
    v_exp_f32 v19, v19
    v_exp_f32 v20, v20
    v_perm_b32 v17, v19, v18, s3
    v_mfma_f32_32x32x16_bf16 v[32:47], v[112:115], v[72:75], 0
    v_exp_f32 v21, v21
    v_exp_f32 v22, v22
    v_perm_b32 v18, v21, v20, s3
    v_exp_f32 v23, v23
    v_mfma_f32_32x32x16_bf16 v[32:47], v[116:119], v[76:79], v[32:47]
    buffer_load_dwordx4 v[192:195], v4, s[32:35], s67 offen offset:2048 sc1
    v_exp_f32 v24, v24
    v_perm_b32 v19, v23, v22, s3
    v_exp_f32 v25, v25
    v_exp_f32 v26, v26
    v_perm_b32 v20, v25, v24, s3
    v_exp_f32 v27, v27
    v_exp_f32 v28, v28
    v_perm_b32 v21, v27, v26, s3
    v_mfma_f32_32x32x16_bf16 a[240:255], v[120:123], v[16:19], a[240:255]
    s_add_u32 m0, s69, 57344
    s_nop 0
    buffer_load_dwordx4 v4, s[32:35], s20 offen offset:0 sc1 lds
    v_exp_f32 v29, v29
    v_exp_f32 v30, v30
    v_perm_b32 v22, v29, v28, s3
    v_exp_f32 v31, v31
    v_exp_f32 v32, v32
    v_perm_b32 v23, v31, v30, s3
    v_exp_f32 v33, v33
    v_exp_f32 v34, v34
    v_mfma_f32_32x32x16_bf16 a[240:255], v[124:127], v[20:23], a[240:255]
    buffer_load_dwordx4 v[112:115], v4, s[32:35], s92 offen offset:0 sc1
    v_perm_b32 v32, v33, v32, s3
    v_exp_f32 v35, v35
    v_exp_f32 v36, v36
    v_perm_b32 v33, v35, v34, s3
    s_waitcnt vmcnt(14)
    v_mfma_f32_32x32x16_bf16 v[16:31], v[80:83], v[48:51], 0
    v_exp_f32 v37, v37
    v_exp_f32 v38, v38
    v_perm_b32 v34, v37, v36, s3
    v_exp_f32 v39, v39
    v_mfma_f32_32x32x16_bf16 v[16:31], v[84:87], v[52:55], v[16:31]
    buffer_load_dwordx4 v[196:199], v4, s[32:35], s67 offen offset:3072 sc1
    v_exp_f32 v40, v40
    v_perm_b32 v35, v39, v38, s3
    v_exp_f32 v41, v41
    v_exp_f32 v42, v42
    v_perm_b32 v36, v41, v40, s3
    v_exp_f32 v43, v43
    v_exp_f32 v44, v44
    v_perm_b32 v37, v43, v42, s3
    v_mfma_f32_32x32x16_bf16 v[128:143], v[120:123], v[32:35], v[128:143]
    buffer_load_dwordx4 v4, s[32:35], s20 offen offset:1024 sc1 lds
    v_exp_f32 v45, v45
    v_exp_f32 v46, v46
    v_perm_b32 v38, v45, v44, s3
    v_exp_f32 v47, v47
    v_exp_f32 v16, v16
    v_perm_b32 v39, v47, v46, s3
    v_exp_f32 v17, v17
    v_exp_f32 v18, v18
    v_mfma_f32_32x32x16_bf16 v[128:143], v[124:127], v[36:39], v[128:143]
    buffer_load_dwordx4 v[116:119], v4, s[32:35], s92 offen offset:1024 sc1
    v_perm_b32 v16, v17, v16, s3
    v_exp_f32 v19, v19
    v_exp_f32 v20, v20
    v_perm_b32 v17, v19, v18, s3
    v_mfma_f32_32x32x16_bf16 v[32:47], v[80:83], v[56:59], 0
    v_exp_f32 v21, v21
    v_exp_f32 v22, v22
    v_perm_b32 v18, v21, v20, s3
    v_exp_f32 v23, v23
    v_mfma_f32_32x32x16_bf16 v[32:47], v[84:87], v[60:63], v[32:47]
    buffer_load_dwordx4 v[200:203], v0, s[32:35], s67 offen offset:0 sc1
    v_exp_f32 v24, v24
    v_perm_b32 v19, v23, v22, s3
    v_exp_f32 v25, v25
    v_exp_f32 v26, v26
    v_perm_b32 v20, v25, v24, s3
    v_exp_f32 v27, v27
    v_exp_f32 v28, v28
    v_perm_b32 v21, v27, v26, s3
    v_mfma_f32_32x32x16_bf16 a[208:223], v[88:91], v[16:19], a[208:223]
    buffer_load_dwordx4 v4, s[32:35], s20 offen offset:2048 sc1 lds
    v_exp_f32 v29, v29
    v_exp_f32 v30, v30
    v_perm_b32 v22, v29, v28, s3
    v_exp_f32 v31, v31
    v_exp_f32 v32, v32
    v_perm_b32 v23, v31, v30, s3
    v_exp_f32 v33, v33
    v_exp_f32 v34, v34
    v_mfma_f32_32x32x16_bf16 a[208:223], v[92:95], v[20:23], a[208:223]
    buffer_load_dwordx4 v[120:123], v4, s[32:35], s92 offen offset:2048 sc1
    v_perm_b32 v32, v33, v32, s3
    v_exp_f32 v35, v35
    v_exp_f32 v36, v36
    v_perm_b32 v33, v35, v34, s3
    v_mfma_f32_32x32x16_bf16 v[16:31], v[80:83], v[64:67], 0
    v_exp_f32 v37, v37
    v_exp_f32 v38, v38
    v_perm_b32 v34, v37, v36, s3
    v_exp_f32 v39, v39
    v_mfma_f32_32x32x16_bf16 v[16:31], v[84:87], v[68:71], v[16:31]
    buffer_load_dwordx4 v4, s[32:35], s20 offen offset:3072 sc1 lds
    v_exp_f32 v40, v40
    v_perm_b32 v35, v39, v38, s3
    v_exp_f32 v41, v41
    v_exp_f32 v42, v42
    v_perm_b32 v36, v41, v40, s3
    v_exp_f32 v43, v43
    v_exp_f32 v44, v44
    v_perm_b32 v37, v43, v42, s3
    v_mfma_f32_32x32x16_bf16 a[224:239], v[88:91], v[32:35], a[224:239]
    s_add_u32 m0, s69, 61440
    s_nop 0
    buffer_load_dwordx4 v0, s[32:35], s20 offen offset:0 sc1 lds
    v_exp_f32 v45, v45
    v_exp_f32 v46, v46
    v_perm_b32 v38, v45, v44, s3
    v_exp_f32 v47, v47
    v_exp_f32 v16, v16
    v_perm_b32 v39, v47, v46, s3
    v_exp_f32 v17, v17
    v_exp_f32 v18, v18
    v_mfma_f32_32x32x16_bf16 a[224:239], v[92:95], v[36:39], a[224:239]
    buffer_load_dwordx4 v[124:127], v4, s[32:35], s92 offen offset:3072 sc1
    v_perm_b32 v16, v17, v16, s3
    v_exp_f32 v19, v19
    v_exp_f32 v20, v20
    v_perm_b32 v17, v19, v18, s3
    v_mfma_f32_32x32x16_bf16 v[32:47], v[80:83], v[72:75], 0
    v_exp_f32 v21, v21
    v_exp_f32 v22, v22
    v_perm_b32 v18, v21, v20, s3
    v_exp_f32 v23, v23
    v_mfma_f32_32x32x16_bf16 v[32:47], v[84:87], v[76:79], v[32:47]
    buffer_load_dwordx4 v[204:207], v0, s[32:35], s67 offen offset:1024 sc1
    v_exp_f32 v24, v24
    v_perm_b32 v19, v23, v22, s3
    v_exp_f32 v25, v25
    v_exp_f32 v26, v26
    v_perm_b32 v20, v25, v24, s3
    v_exp_f32 v27, v27
    v_exp_f32 v28, v28
    v_perm_b32 v21, v27, v26, s3
    v_mfma_f32_32x32x16_bf16 a[240:255], v[88:91], v[16:19], a[240:255]
    buffer_load_dwordx4 v0, s[32:35], s20 offen offset:1024 sc1 lds
    v_exp_f32 v29, v29
    v_exp_f32 v30, v30
    v_perm_b32 v22, v29, v28, s3
    v_exp_f32 v31, v31
    v_exp_f32 v32, v32
    v_perm_b32 v23, v31, v30, s3
    v_exp_f32 v33, v33
    v_exp_f32 v34, v34
    v_mfma_f32_32x32x16_bf16 a[240:255], v[92:95], v[20:23], a[240:255]
    buffer_load_dwordx4 v[80:83], v4, s[32:35], s93 offen offset:0 sc1
    v_perm_b32 v32, v33, v32, s3
    v_exp_f32 v35, v35
    v_exp_f32 v36, v36
    v_perm_b32 v33, v35, v34, s3
    s_waitcnt vmcnt(15)
    v_mfma_f32_32x32x16_bf16 v[16:31], v[96:99], v[48:51], 0
    v_exp_f32 v37, v37
    v_exp_f32 v38, v38
    v_perm_b32 v34, v37, v36, s3
    v_exp_f32 v39, v39
    v_mfma_f32_32x32x16_bf16 v[16:31], v[100:103], v[52:55], v[16:31]
    buffer_load_dwordx4 v[224:227], v0, s[32:35], s67 offen offset:2048 sc1
    v_exp_f32 v40, v40
    v_perm_b32 v35, v39, v38, s3
    v_exp_f32 v41, v41
    v_exp_f32 v42, v42
    v_perm_b32 v36, v41, v40, s3
    v_exp_f32 v43, v43
    v_exp_f32 v44, v44
    v_perm_b32 v37, v43, v42, s3
    v_mfma_f32_32x32x16_bf16 v[128:143], v[88:91], v[32:35], v[128:143]
    buffer_load_dwordx4 v0, s[32:35], s20 offen offset:2048 sc1 lds
    v_exp_f32 v45, v45
    v_exp_f32 v46, v46
    v_perm_b32 v38, v45, v44, s3
    v_exp_f32 v47, v47
    v_exp_f32 v16, v16
    v_perm_b32 v39, v47, v46, s3
    v_exp_f32 v17, v17
    v_exp_f32 v18, v18
    v_mfma_f32_32x32x16_bf16 v[128:143], v[92:95], v[36:39], v[128:143]
    buffer_store_dword v12, v11, s[32:35], s98 offen sc1
    v_perm_b32 v16, v17, v16, s3
    v_exp_f32 v19, v19
    v_exp_f32 v20, v20
    v_perm_b32 v17, v19, v18, s3
    v_mfma_f32_32x32x16_bf16 v[32:47], v[96:99], v[56:59], 0
    v_exp_f32 v21, v21
    v_exp_f32 v22, v22
    v_perm_b32 v18, v21, v20, s3
    v_exp_f32 v23, v23
    v_mfma_f32_32x32x16_bf16 v[32:47], v[100:103], v[60:63], v[32:47]
    buffer_load_dwordx4 v[84:87], v4, s[32:35], s93 offen offset:1024 sc1
    v_exp_f32 v24, v24
    v_perm_b32 v19, v23, v22, s3
    v_exp_f32 v25, v25
    v_exp_f32 v26, v26
    v_perm_b32 v20, v25, v24, s3
    v_exp_f32 v27, v27
    v_exp_f32 v28, v28
    v_perm_b32 v21, v27, v26, s3
    v_mfma_f32_32x32x16_bf16 a[208:223], v[104:107], v[16:19], a[208:223]
    buffer_load_dwordx4 v[228:231], v4, s[32:35], s68 offen offset:0 sc1
    v_exp_f32 v29, v29
    v_exp_f32 v30, v30
    v_perm_b32 v22, v29, v28, s3
    v_exp_f32 v31, v31
    v_exp_f32 v32, v32
    v_perm_b32 v23, v31, v30, s3
    v_exp_f32 v33, v33
    v_exp_f32 v34, v34
    v_mfma_f32_32x32x16_bf16 a[208:223], v[108:111], v[20:23], a[208:223]
    buffer_load_dwordx4 v[88:91], v4, s[32:35], s93 offen offset:2048 sc1
    v_perm_b32 v32, v33, v32, s3
    v_exp_f32 v35, v35
    v_exp_f32 v36, v36
    v_perm_b32 v33, v35, v34, s3
    v_mfma_f32_32x32x16_bf16 v[16:31], v[96:99], v[64:67], 0
    v_exp_f32 v37, v37
    v_exp_f32 v38, v38
    v_perm_b32 v34, v37, v36, s3
    v_exp_f32 v39, v39
    v_mfma_f32_32x32x16_bf16 v[16:31], v[100:103], v[68:71], v[16:31]
    buffer_load_dwordx4 v[232:235], v4, s[32:35], s68 offen offset:1024 sc1
    v_exp_f32 v40, v40
    v_perm_b32 v35, v39, v38, s3
    v_exp_f32 v41, v41
    v_exp_f32 v42, v42
    v_perm_b32 v36, v41, v40, s3
    v_exp_f32 v43, v43
    v_exp_f32 v44, v44
    v_perm_b32 v37, v43, v42, s3
    v_mfma_f32_32x32x16_bf16 a[224:239], v[104:107], v[32:35], a[224:239]
    s_mov_b32 m0, s96
    s_nop 0
    buffer_load_dwordx4 v4, s[32:35], s21 offen offset:0 sc1 lds
    v_exp_f32 v45, v45
    v_exp_f32 v46, v46
    v_perm_b32 v38, v45, v44, s3
    v_exp_f32 v47, v47
    v_exp_f32 v16, v16
    v_perm_b32 v39, v47, v46, s3
    v_exp_f32 v17, v17
    v_exp_f32 v18, v18
    v_mfma_f32_32x32x16_bf16 a[224:239], v[108:111], v[36:39], a[224:239]
    buffer_load_dword v11, v208, s[44:47], 0 offen offset:0
    v_perm_b32 v16, v17, v16, s3
    v_exp_f32 v19, v19
    v_exp_f32 v20, v20
    v_perm_b32 v17, v19, v18, s3
    v_mfma_f32_32x32x16_bf16 v[32:47], v[96:99], v[72:75], 0
    v_exp_f32 v21, v21
    v_exp_f32 v22, v22
    v_perm_b32 v18, v21, v20, s3
    v_exp_f32 v23, v23
    v_mfma_f32_32x32x16_bf16 v[32:47], v[100:103], v[76:79], v[32:47]
    buffer_load_dwordx4 v[92:95], v4, s[32:35], s93 offen offset:3072 sc1
    v_exp_f32 v24, v24
    v_perm_b32 v19, v23, v22, s3
    v_exp_f32 v25, v25
    v_exp_f32 v26, v26
    v_perm_b32 v20, v25, v24, s3
    v_exp_f32 v27, v27
    v_exp_f32 v28, v28
    v_perm_b32 v21, v27, v26, s3
    v_mfma_f32_32x32x16_bf16 a[240:255], v[104:107], v[16:19], a[240:255]
    buffer_load_dwordx4 v[236:239], v4, s[32:35], s68 offen offset:2048 sc1
    v_exp_f32 v29, v29
    v_exp_f32 v30, v30
    v_perm_b32 v22, v29, v28, s3
    v_exp_f32 v31, v31
    v_exp_f32 v32, v32
    v_perm_b32 v23, v31, v30, s3
    v_exp_f32 v33, v33
    v_exp_f32 v34, v34
    v_mfma_f32_32x32x16_bf16 a[240:255], v[108:111], v[20:23], a[240:255]
    buffer_load_dword v12, v208, s[44:47], 0 offen offset:4
    v_perm_b32 v32, v33, v32, s3
    v_exp_f32 v35, v35
    v_exp_f32 v36, v36
    v_perm_b32 v33, v35, v34, s3
    s_waitcnt vmcnt(15)
    v_mfma_f32_32x32x16_bf16 v[16:31], v[112:115], v[48:51], 0
    v_exp_f32 v37, v37
    v_exp_f32 v38, v38
    v_perm_b32 v34, v37, v36, s3
    v_exp_f32 v39, v39
    v_mfma_f32_32x32x16_bf16 v[16:31], v[116:119], v[52:55], v[16:31]
    buffer_load_dwordx4 v[240:243], v4, s[32:35], s68 offen offset:3072 sc1
    v_exp_f32 v40, v40
    v_perm_b32 v35, v39, v38, s3
    v_exp_f32 v41, v41
    v_exp_f32 v42, v42
    v_perm_b32 v36, v41, v40, s3
    v_exp_f32 v43, v43
    v_exp_f32 v44, v44
    v_perm_b32 v37, v43, v42, s3
    v_mfma_f32_32x32x16_bf16 v[128:143], v[104:107], v[32:35], v[128:143]
    buffer_load_dwordx4 v4, s[32:35], s21 offen offset:1024 sc1 lds
    v_exp_f32 v45, v45
    v_exp_f32 v46, v46
    v_perm_b32 v38, v45, v44, s3
    v_exp_f32 v47, v47
    v_exp_f32 v16, v16
    v_perm_b32 v39, v47, v46, s3
    v_exp_f32 v17, v17
    v_exp_f32 v18, v18
    v_mfma_f32_32x32x16_bf16 v[128:143], v[108:111], v[36:39], v[128:143]
    buffer_load_dwordx4 v[244:247], v0, s[32:35], s68 offen offset:0 sc1
    v_perm_b32 v16, v17, v16, s3
    v_exp_f32 v19, v19
    v_exp_f32 v20, v20
    v_perm_b32 v17, v19, v18, s3
    v_mfma_f32_32x32x16_bf16 v[32:47], v[112:115], v[56:59], 0
    v_exp_f32 v21, v21
    v_exp_f32 v22, v22
    v_perm_b32 v18, v21, v20, s3
    v_exp_f32 v23, v23
    v_mfma_f32_32x32x16_bf16 v[32:47], v[116:119], v[60:63], v[32:47]
    buffer_load_dwordx4 v4, s[32:35], s21 offen offset:2048 sc1 lds
    v_exp_f32 v24, v24
    v_perm_b32 v19, v23, v22, s3
    v_exp_f32 v25, v25
    v_exp_f32 v26, v26
    v_perm_b32 v20, v25, v24, s3
    v_exp_f32 v27, v27
    v_exp_f32 v28, v28
    v_perm_b32 v21, v27, v26, s3
    v_mfma_f32_32x32x16_bf16 a[208:223], v[120:123], v[16:19], a[208:223]
    s_mov_b32 m0, s60
    s_nop 0
    buffer_load_dwordx4 v4, s[32:35], s21 offen offset:3072 sc1 lds
    v_exp_f32 v29, v29
    v_exp_f32 v30, v30
    v_perm_b32 v22, v29, v28, s3
    v_exp_f32 v31, v31
    v_exp_f32 v32, v32
    v_perm_b32 v23, v31, v30, s3
    v_exp_f32 v33, v33
    v_exp_f32 v34, v34
    v_mfma_f32_32x32x16_bf16 a[208:223], v[124:127], v[20:23], a[208:223]
    buffer_load_dwordx2 v[100:101], v219, s[36:39], 0 offen offset:0
    v_perm_b32 v32, v33, v32, s3
    v_exp_f32 v35, v35
    v_exp_f32 v36, v36
    v_perm_b32 v33, v35, v34, s3
    v_mfma_f32_32x32x16_bf16 v[16:31], v[112:115], v[64:67], 0
    v_exp_f32 v37, v37
    v_exp_f32 v38, v38
    v_perm_b32 v34, v37, v36, s3
    v_exp_f32 v39, v39
    v_mfma_f32_32x32x16_bf16 v[16:31], v[116:119], v[68:71], v[16:31]
    buffer_load_dwordx4 v[248:251], v0, s[32:35], s68 offen offset:1024 sc1
    v_exp_f32 v40, v40
    v_perm_b32 v35, v39, v38, s3
    v_exp_f32 v41, v41
    v_exp_f32 v42, v42
    v_perm_b32 v36, v41, v40, s3
    v_exp_f32 v43, v43
    v_exp_f32 v44, v44
    v_perm_b32 v37, v43, v42, s3
    v_mfma_f32_32x32x16_bf16 a[224:239], v[120:123], v[32:35], a[224:239]
    s_add_u32 s12, s11, 0
    buffer_load_dwordx4 a[0:3], v7, s[32:35], s12 offen sc1
    v_exp_f32 v45, v45
    v_exp_f32 v46, v46
    v_perm_b32 v38, v45, v44, s3
    v_exp_f32 v47, v47
    v_exp_f32 v16, v16
    v_perm_b32 v39, v47, v46, s3
    v_exp_f32 v17, v17
    v_exp_f32 v18, v18
    v_mfma_f32_32x32x16_bf16 a[224:239], v[124:127], v[36:39], a[224:239]
    buffer_load_dwordx2 v[102:103], v219, s[36:39], 0 offen offset:32
    v_perm_b32 v16, v17, v16, s3
    v_exp_f32 v19, v19
    v_exp_f32 v20, v20
    v_perm_b32 v17, v19, v18, s3
    v_mfma_f32_32x32x16_bf16 v[32:47], v[112:115], v[72:75], 0
    v_exp_f32 v21, v21
    v_exp_f32 v22, v22
    v_perm_b32 v18, v21, v20, s3
    v_exp_f32 v23, v23
    v_mfma_f32_32x32x16_bf16 v[32:47], v[116:119], v[76:79], v[32:47]
    buffer_load_dwordx4 v[252:255], v0, s[32:35], s68 offen offset:2048 sc1
    v_exp_f32 v24, v24
    v_perm_b32 v19, v23, v22, s3
    v_exp_f32 v25, v25
    v_exp_f32 v26, v26
    v_perm_b32 v20, v25, v24, s3
    v_exp_f32 v27, v27
    v_exp_f32 v28, v28
    v_perm_b32 v21, v27, v26, s3
    v_mfma_f32_32x32x16_bf16 a[240:255], v[120:123], v[16:19], a[240:255]
    buffer_load_dwordx4 a[4:7], v8, s[32:35], s12 offen sc1
    v_exp_f32 v29, v29
    v_exp_f32 v30, v30
    v_perm_b32 v22, v29, v28, s3
    v_exp_f32 v31, v31
    v_exp_f32 v32, v32
    v_perm_b32 v23, v31, v30, s3
    v_exp_f32 v33, v33
    v_exp_f32 v34, v34
    v_mfma_f32_32x32x16_bf16 a[240:255], v[124:127], v[20:23], a[240:255]
    buffer_load_dword v9, v10, s[32:35], 0 offen sc1
    v_perm_b32 v32, v33, v32, s3
    v_exp_f32 v35, v35
    v_exp_f32 v36, v36
    v_perm_b32 v33, v35, v34, s3
    s_waitcnt vmcnt(14)
    v_mfma_f32_32x32x16_bf16 v[16:31], v[80:83], v[48:51], 0
    v_exp_f32 v37, v37
    v_exp_f32 v38, v38
    v_perm_b32 v34, v37, v36, s3
    v_exp_f32 v39, v39
    v_mfma_f32_32x32x16_bf16 v[16:31], v[84:87], v[52:55], v[16:31]
    buffer_load_dwordx2 v[104:105], v219, s[36:39], 0 offen offset:128
    v_exp_f32 v40, v40
    v_perm_b32 v35, v39, v38, s3
    v_exp_f32 v41, v41
    v_exp_f32 v42, v42
    v_perm_b32 v36, v41, v40, s3
    v_exp_f32 v43, v43
    v_exp_f32 v44, v44
    v_perm_b32 v37, v43, v42, s3
    v_mfma_f32_32x32x16_bf16 v[128:143], v[120:123], v[32:35], v[128:143]
    s_add_u32 s12, s58, 0
    buffer_load_dwordx4 a[8:11], v7, s[32:35], s12 offen sc1
    v_exp_f32 v45, v45
    v_exp_f32 v46, v46
    v_perm_b32 v38, v45, v44, s3
    v_exp_f32 v47, v47
    v_exp_f32 v16, v16
    v_perm_b32 v39, v47, v46, s3
    v_exp_f32 v17, v17
    v_exp_f32 v18, v18
    v_mfma_f32_32x32x16_bf16 v[128:143], v[124:127], v[36:39], v[128:143]
    buffer_load_dwordx2 v[106:107], v219, s[36:39], 0 offen offset:160
    v_perm_b32 v16, v17, v16, s3
    v_exp_f32 v19, v19
    v_exp_f32 v20, v20
    v_perm_b32 v17, v19, v18, s3
    v_mfma_f32_32x32x16_bf16 v[32:47], v[80:83], v[56:59], 0
    v_exp_f32 v21, v21
    v_exp_f32 v22, v22
    v_perm_b32 v18, v21, v20, s3
    v_exp_f32 v23, v23
    v_mfma_f32_32x32x16_bf16 v[32:47], v[84:87], v[60:63], v[32:47]
    buffer_load_dwordx4 a[12:15], v8, s[32:35], s12 offen sc1
    v_exp_f32 v24, v24
    v_perm_b32 v19, v23, v22, s3
    v_exp_f32 v25, v25
    v_exp_f32 v26, v26
    v_perm_b32 v20, v25, v24, s3
    v_exp_f32 v27, v27
    v_exp_f32 v28, v28
    v_perm_b32 v21, v27, v26, s3
    v_mfma_f32_32x32x16_bf16 a[208:223], v[88:91], v[16:19], a[208:223]
    s_add_u32 s12, s59, 0
    buffer_load_dwordx4 a[16:19], v7, s[32:35], s12 offen sc1
    v_exp_f32 v29, v29
    v_exp_f32 v30, v30
    v_perm_b32 v22, v29, v28, s3
    v_exp_f32 v31, v31
    v_exp_f32 v32, v32
    v_perm_b32 v23, v31, v30, s3
    v_exp_f32 v33, v33
    v_exp_f32 v34, v34
    v_mfma_f32_32x32x16_bf16 a[208:223], v[92:95], v[20:23], a[208:223]
    buffer_load_dwordx4 a[20:23], v8, s[32:35], s12 offen sc1
    v_perm_b32 v32, v33, v32, s3
    v_exp_f32 v35, v35
    v_exp_f32 v36, v36
    v_perm_b32 v33, v35, v34, s3
    v_mfma_f32_32x32x16_bf16 v[16:31], v[80:83], v[64:67], 0
    v_exp_f32 v37, v37
    v_exp_f32 v38, v38
    v_perm_b32 v34, v37, v36, s3
    v_exp_f32 v39, v39
    v_mfma_f32_32x32x16_bf16 v[16:31], v[84:87], v[68:71], v[16:31]
    s_add_u32 s12, s26, 0
    buffer_load_dwordx4 a[24:27], v7, s[32:35], s12 offen sc1
    v_exp_f32 v40, v40
    v_perm_b32 v35, v39, v38, s3
    v_exp_f32 v41, v41
    v_exp_f32 v42, v42
    v_perm_b32 v36, v41, v40, s3
    v_exp_f32 v43, v43
    v_exp_f32 v44, v44
    v_perm_b32 v37, v43, v42, s3
    v_mfma_f32_32x32x16_bf16 a[224:239], v[88:91], v[32:35], a[224:239]
    buffer_load_dwordx4 a[28:31], v8, s[32:35], s12 offen sc1
    ds_write_b128 v220, a[208:211] offset:0
    ds_write_b128 v220, a[212:215] offset:1024
    v_exp_f32 v45, v45
    v_exp_f32 v46, v46
    v_perm_b32 v38, v45, v44, s3
    v_exp_f32 v47, v47
    v_exp_f32 v16, v16
    v_perm_b32 v39, v47, v46, s3
    v_exp_f32 v17, v17
    v_exp_f32 v18, v18
    v_mfma_f32_32x32x16_bf16 a[224:239], v[92:95], v[36:39], a[224:239]
    s_add_u32 s12, s11, 2048
    buffer_load_dwordx4 a[32:35], v7, s[32:35], s12 offen sc1
    ds_write_b128 v220, a[216:219] offset:2048
    ds_write_b128 v220, a[220:223] offset:3072
    v_perm_b32 v16, v17, v16, s3
    v_exp_f32 v19, v19
    v_exp_f32 v20, v20
    v_perm_b32 v17, v19, v18, s3
    v_mfma_f32_32x32x16_bf16 v[32:47], v[80:83], v[72:75], 0
    v_exp_f32 v21, v21
    v_exp_f32 v22, v22
    v_perm_b32 v18, v21, v20, s3
    v_exp_f32 v23, v23
    v_mfma_f32_32x32x16_bf16 v[32:47], v[84:87], v[76:79], v[32:47]
    buffer_load_dwordx4 a[36:39], v8, s[32:35], s12 offen sc1
    v_exp_f32 v24, v24
    v_perm_b32 v19, v23, v22, s3
    v_exp_f32 v25, v25
    v_exp_f32 v26, v26
    v_perm_b32 v20, v25, v24, s3
    v_exp_f32 v27, v27
    v_exp_f32 v28, v28
    v_perm_b32 v21, v27, v26, s3
    v_mfma_f32_32x32x16_bf16 a[240:255], v[88:91], v[16:19], a[240:255]
    ds_write_b128 v221, a[224:227] offset:4096
    ds_write_b128 v221, a[228:231] offset:5120
    v_exp_f32 v29, v29
    v_exp_f32 v30, v30
    v_perm_b32 v22, v29, v28, s3
    v_exp_f32 v31, v31
    v_exp_f32 v32, v32
    v_perm_b32 v23, v31, v30, s3
    v_exp_f32 v33, v33
    v_exp_f32 v34, v34
    v_mfma_f32_32x32x16_bf16 a[240:255], v[92:95], v[20:23], a[240:255]
    ds_write_b128 v221, a[232:235] offset:6144
    ds_write_b128 v221, a[236:239] offset:7168
    v_perm_b32 v32, v33, v32, s3
    v_exp_f32 v35, v35
    v_exp_f32 v36, v36
    v_perm_b32 v33, v35, v34, s3
    v_exp_f32 v37, v37
    v_exp_f32 v38, v38
    v_perm_b32 v34, v37, v36, s3
    v_exp_f32 v39, v39
    v_exp_f32 v40, v40
    v_perm_b32 v35, v39, v38, s3
    v_exp_f32 v41, v41
    v_exp_f32 v42, v42
    v_perm_b32 v36, v41, v40, s3
    v_exp_f32 v43, v43
    v_exp_f32 v44, v44
    v_perm_b32 v37, v43, v42, s3
    v_mfma_f32_32x32x16_bf16 v[128:143], v[88:91], v[32:35], v[128:143]
    ds_write_b128 v222, a[240:243] offset:8192
    ds_write_b128 v222, a[244:247] offset:9216
    v_exp_f32 v45, v45
    v_exp_f32 v46, v46
    v_perm_b32 v38, v45, v44, s3
    v_exp_f32 v47, v47
    ds_write_b128 v222, a[248:251] offset:10240
    v_perm_b32 v39, v47, v46, s3
    ds_write_b128 v222, a[252:255] offset:11264
    s_nop 0
    v_mfma_f32_32x32x16_bf16 v[128:143], v[92:95], v[36:39], v[128:143]
L_comb:
    s_waitcnt vmcnt(10)
    v_cmp_ne_u32 vcc, s31, v9
    s_nop 1
    s_cbranch_vccnz L_slow4
L_back4:
    s_waitcnt lgkmcnt(0)
    s_barrier
    ds_read_b128 v[16:19], v223 offset:0
    ds_read_b128 v[20:23], v223 offset:1024
    ds_read_b128 v[24:27], v223 offset:2048
    ds_read_b128 v[28:31], v223 offset:3072
    s_add_u32 s12, s58, 2048
    buffer_load_dwordx4 a[40:43], v7, s[32:35], s12 offen sc1
    ds_read_b128 v[32:35], v223 offset:4096
    ds_read_b128 v[36:39], v223 offset:5120
    ds_read_b128 v[40:43], v223 offset:6144
    ds_read_b128 v[44:47], v223 offset:7168
    buffer_load_dwordx4 a[44:47], v8, s[32:35], s12 offen sc1
    ds_read_b128 v[112:115], v223 offset:8192
    ds_read_b128 v[116:119], v223 offset:9216
    ds_read_b128 v[120:123], v223 offset:10240
    ds_read_b128 v[124:127], v223 offset:11264
    s_add_u32 s12, s59, 2048
    buffer_load_dwordx4 a[48:51], v7, s[32:35], s12 offen sc1
    v_mov_b32 v80, 0x30800000
    v_mov_b32 v81, 0x4e800000
    s_lshl_b32 s52, s30, 2
    s_add_u32 s52, s52, 156928
    v_mov_b32 v82, s52
    s_waitcnt lgkmcnt(8)
    buffer_load_dwordx4 a[52:55], v8, s[32:35], s12 offen sc1
    v_pk_add_f32 v[128:129], v[128:129], v[16:17]
    v_pk_add_f32 v[130:131], v[130:131], v[18:19]
    v_pk_add_f32 v[132:133], v[132:133], v[20:21]
    v_pk_add_f32 v[134:135], v[134:135], v[22:23]
    v_pk_add_f32 v[136:137], v[136:137], v[24:25]
    v_pk_add_f32 v[138:139], v[138:139], v[26:27]
    v_pk_add_f32 v[140:141], v[140:141], v[28:29]
    v_pk_add_f32 v[142:143], v[142:143], v[30:31]
    s_waitcnt lgkmcnt(4)
    s_add_u32 s12, s26, 2048
    buffer_load_dwordx4 a[56:59], v7, s[32:35], s12 offen sc1
    v_pk_add_f32 v[128:129], v[128:129], v[32:33]
    v_pk_add_f32 v[130:131], v[130:131], v[34:35]
    v_pk_add_f32 v[132:133], v[132:133], v[36:37]
    v_pk_add_f32 v[134:135], v[134:135], v[38:39]
    v_pk_add_f32 v[136:137], v[136:137], v[40:41]
    v_pk_add_f32 v[138:139], v[138:139], v[42:43]
    v_pk_add_f32 v[140:141], v[140:141], v[44:45]
    v_pk_add_f32 v[142:143], v[142:143], v[46:47]
    s_waitcnt lgkmcnt(0)
    buffer_load_dwordx4 a[60:63], v8, s[32:35], s12 offen sc1
    v_pk_add_f32 v[128:129], v[128:129], v[112:113]
    v_pk_add_f32 v[130:131], v[130:131], v[114:115]
    v_pk_add_f32 v[132:133], v[132:133], v[116:117]
    v_pk_add_f32 v[134:135], v[134:135], v[118:119]
    v_pk_add_f32 v[136:137], v[136:137], v[120:121]
    v_pk_add_f32 v[138:139], v[138:139], v[122:123]
    v_pk_add_f32 v[140:141], v[140:141], v[124:125]
    v_pk_add_f32 v[142:143], v[142:143], v[126:127]
    v_mov_b32 v16, v140
    v_mov_b32 v17, v140
    s_add_u32 s12, s11, 4096
    buffer_load_dwordx4 a[64:67], v7, s[32:35], s12 offen sc1
    v_permlane32_swap_b32 v16, v17
    v_rcp_f32 v16, v17
    v_med3_f32 v80, v17, v80, v81
    v_cmp_neq_f32 vcc, v80, v17
    v_pk_mul_f32 v[128:129], v[128:129], v[16:17] op_sel_hi:[1,0]
    v_pk_mul_f32 v[130:131], v[130:131], v[16:17] op_sel_hi:[1,0]
    v_cvt_pk_bf16_f32 v128, v128, v129
    v_cvt_pk_bf16_f32 v129, v130, v131
    s_or_b32 s52, vcc_lo, vcc_hi
    ds_write_b64 v210, v[128:129] offset:0
    v_pk_mul_f32 v[132:133], v[132:133], v[16:17] op_sel_hi:[1,0]
    v_pk_mul_f32 v[134:135], v[134:135], v[16:17] op_sel_hi:[1,0]
    v_cvt_pk_bf16_f32 v132, v132, v133
    v_cvt_pk_bf16_f32 v133, v134, v135
    v_mov_b32 v83, s52
    ds_write_b64 v210, v[132:133] offset:16
    buffer_load_dwordx4 a[68:71], v8, s[32:35], s12 offen sc1
    v_pk_mul_f32 v[136:137], v[136:137], v[16:17] op_sel_hi:[1,0]
    v_pk_mul_f32 v[138:139], v[138:139], v[16:17] op_sel_hi:[1,0]
    v_cvt_pk_bf16_f32 v136, v136, v137
    v_cvt_pk_bf16_f32 v137, v138, v139
    ds_write_b64 v210, v[136:137] offset:32
    v_pk_mul_f32 v[140:141], v[140:141], v[16:17] op_sel_hi:[1,0]
    v_pk_mul_f32 v[142:143], v[142:143], v[16:17] op_sel_hi:[1,0]
    v_cvt_pk_bf16_f32 v140, v140, v141
    v_cvt_pk_bf16_f32 v141, v142, v143
    s_mov_b32 exec_hi, 0
    ds_write_b64 v210, v[140:141] offset:48
    ds_write_b32 v82, v83
    s_mov_b32 exec_hi, -1
    v_mov_b32 v82, 156928
    s_add_u32 s12, s58, 4096
    buffer_load_dwordx4 a[72:75], v7, s[32:35], s12 offen sc1
    s_waitcnt lgkmcnt(0)
    s_barrier
    ds_read_b128 v[84:87], v82
    ds_read_b128 v[16:19], v211 offset:0
    ds_read_b128 v[20:23], v211 offset:64
    ds_read_b128 v[24:27], v211 offset:128
    ds_read_b128 v[28:31], v211 offset:192
    ds_read_b128 v[32:35], v211 offset:256
    ds_read_b128 v[36:39], v211 offset:320
    ds_read_b128 v[40:43], v211 offset:384
    buffer_load_dwordx4 a[76:79], v8, s[32:35], s12 offen sc1
    s_waitcnt lgkmcnt(7)
    v_or3_b32 v84, v84, v85, v86
    v_or_b32 v84, v84, v87
    v_cmp_lt_u32 vcc, s74, v84
    s_nop 1
    s_cbranch_vccnz L_fb
    s_waitcnt lgkmcnt(6)
    v_mfma_f32_16x16x32_bf16 v[72:75], a[108:111], v[16:19], 0
    s_add_u32 s12, s59, 4096
    buffer_load_dwordx4 a[80:83], v7, s[32:35], s12 offen sc1
    v_mov_b32 v139, 0x3f803f80
    v_mov_b32 v136, 0xffff0000
    s_waitcnt lgkmcnt(5)
    v_mfma_f32_16x16x32_bf16 v[72:75], a[136:139], v[20:23], v[72:75]
    v_mov_b32 v137, 0x10000
    s_mov_b32 s65, 4325376
    s_waitcnt lgkmcnt(4)
    v_mfma_f32_16x16x32_bf16 v[72:75], a[164:167], v[24:27], v[72:75]
    s_lshl_b32 s52, s48, 4
    s_lshl_b32 s53, s7, 3
    s_waitcnt lgkmcnt(3)
    v_mfma_f32_16x16x32_bf16 v[72:75], a[192:195], v[28:31], v[72:75]
    s_add_u32 s52, s52, s53
    s_lshl_b32 s53, s30, 1
    s_waitcnt lgkmcnt(2)
    v_mfma_f32_16x16x32_bf16 v[72:75], v[156:159], v[32:35], v[72:75]
    buffer_load_dwordx4 a[84:87], v8, s[32:35], s12 offen sc1
    s_add_u32 s52, s52, s53
    s_mul_i32 s52, s52, 14336
    s_waitcnt lgkmcnt(1)
    v_mfma_f32_16x16x32_bf16 v[72:75], v[184:187], v[36:39], v[72:75]
    s_add_u32 s62, s52, 4325376
    s_add_u32 s63, s62, 14336
    s_waitcnt lgkmcnt(0)
    v_mfma_f32_16x16x32_bf16 v[72:75], v[228:231], v[40:43], v[72:75]
    s_lshl_b32 s53, s10, 10
    s_add_u32 s78, s53, s62
    v_mfma_f32_16x16x32_bf16 v[76:79], a[112:115], v[16:19], 0
    v_add_u32 v132, 14336, v4
    v_add_u32 v130, 49152, v4
    v_mfma_f32_16x16x32_bf16 v[76:79], a[140:143], v[20:23], v[76:79]
    s_add_u32 s12, s26, 4096
    buffer_load_dwordx4 a[88:91], v7, s[32:35], s12 offen sc1
    v_add_u32 v131, 106496, v4
    s_add_u32 s79, s78, 1024
    v_mfma_f32_16x16x32_bf16 v[76:79], a[168:171], v[24:27], v[76:79]
    s_cmp_eq_u32 s79, s63
    s_cselect_b32 s79, s62, s79
    s_add_u32 s80, s79, 1024
    v_mfma_f32_16x16x32_bf16 v[76:79], a[196:199], v[28:31], v[76:79]
    s_cmp_eq_u32 s80, s63
    s_cselect_b32 s80, s62, s80
    s_add_u32 s81, s80, 1024
    v_mfma_f32_16x16x32_bf16 v[76:79], v[160:163], v[32:35], v[76:79]
    s_cmp_eq_u32 s81, s63
    s_cselect_b32 s81, s62, s81
    s_add_u32 s82, s81, 1024
    v_mfma_f32_16x16x32_bf16 v[76:79], v[188:191], v[36:39], v[76:79]
    buffer_load_dwordx4 a[92:95], v8, s[32:35], s12 offen sc1
    s_cmp_eq_u32 s82, s63
    s_cselect_b32 s82, s62, s82
    s_add_u32 s83, s82, 1024
    v_mfma_f32_16x16x32_bf16 v[76:79], v[232:235], v[40:43], v[76:79]
    s_cmp_eq_u32 s83, s63
    s_cselect_b32 s83, s62, s83
    s_add_u32 s84, s83, 1024
    v_mfma_f32_16x16x32_bf16 v[80:83], a[116:119], v[16:19], 0
    s_cmp_eq_u32 s84, s63
    s_cselect_b32 s84, s62, s84
    s_add_u32 s85, s84, 1024
    v_mfma_f32_16x16x32_bf16 v[80:83], a[144:147], v[20:23], v[80:83]
    s_cmp_eq_u32 s85, s63
    s_cselect_b32 s85, s62, s85
    s_add_u32 s86, s85, 1024
    v_mfma_f32_16x16x32_bf16 v[80:83], a[172:175], v[24:27], v[80:83]
    s_add_u32 s12, s11, 6144
    buffer_load_dwordx4 a[96:99], v7, s[32:35], s12 offen sc1
    s_cmp_eq_u32 s86, s63
    s_cselect_b32 s86, s62, s86
    s_add_u32 s87, s86, 1024
    v_mfma_f32_16x16x32_bf16 v[80:83], a[200:203], v[28:31], v[80:83]
    v_cvt_pk_bf16_f32 v114, v72, v73
    v_cvt_pk_bf16_f32 v115, v74, v75
    v_mfma_f32_16x16x32_bf16 v[80:83], v[164:167], v[32:35], v[80:83]
    v_cvt_pk_bf16_f32 v116, v76, v77
    v_cvt_pk_bf16_f32 v117, v78, v79
    v_mfma_f32_16x16x32_bf16 v[80:83], v[192:195], v[36:39], v[80:83]
    s_cmp_eq_u32 s87, s63
    s_cselect_b32 s87, s62, s87
    s_add_u32 s88, s87, 1024
    v_mfma_f32_16x16x32_bf16 v[80:83], v[236:239], v[40:43], v[80:83]
    buffer_load_dwordx4 a[100:103], v8, s[32:35], s12 offen sc1
    s_cmp_eq_u32 s88, s63
    s_cselect_b32 s88, s62, s88
    s_add_u32 s89, s88, 1024
    v_mfma_f32_16x16x32_bf16 v[84:87], a[120:123], v[16:19], 0
    s_cmp_eq_u32 s89, s63
    s_cselect_b32 s89, s62, s89
    s_add_u32 s90, s89, 1024
    v_mfma_f32_16x16x32_bf16 v[84:87], a[148:151], v[20:23], v[84:87]
    s_cmp_eq_u32 s90, s63
    s_cselect_b32 s90, s62, s90
    s_add_u32 s91, s90, 1024
    v_mfma_f32_16x16x32_bf16 v[84:87], a[176:179], v[24:27], v[84:87]
    s_cmp_eq_u32 s91, s63
    s_cselect_b32 s91, s62, s91
    v_and_b32 v6, 7, v2
    v_mfma_f32_16x16x32_bf16 v[84:87], a[204:207], v[28:31], v[84:87]
    s_add_u32 s12, s58, 6144
    buffer_load_dwordx4 a[104:107], v7, s[32:35], s12 offen sc1
    v_mul_u32_u24 v212, 912, v6
    v_lshl_add_u32 v212, v3, 3, v212
    v_mfma_f32_16x16x32_bf16 v[84:87], v[168:171], v[32:35], v[84:87]
    s_mul_i32 s53, s30, 224
    s_add_u32 s53, s53, 0
    v_mfma_f32_16x16x32_bf16 v[84:87], v[196:199], v[36:39], v[84:87]
    v_add_u32 v212, s53, v212
    v_and_b32 v221, 8, v2
    v_mfma_f32_16x16x32_bf16 v[84:87], v[240:243], v[40:43], v[84:87]
    v_lshl_add_u32 v212, v221, 3, v212
    s_lshl_b32 s56, s30, 6
    v_mfma_f32_16x16x32_bf16 v[88:91], a[124:127], v[16:19], 0
    s_add_u32 s56, s56, 8192
    v_lshl_add_u32 v221, v6, 3, s56
    v_mfma_f32_16x16x32_bf16 v[88:91], a[152:155], v[20:23], v[88:91]
    v_lshlrev_b32 v220, 3, v6
    v_add_u32 v220, 8192, v220
    v_mfma_f32_16x16x32_bf16 v[88:91], a[180:183], v[24:27], v[88:91]
    v_mul_u32_u24 v213, 912, v6
    v_lshrrev_b32 v6, 3, v1
    v_mfma_f32_16x16x32_bf16 v[88:91], v[144:147], v[28:31], v[88:91]
    v_cvt_pk_bf16_f32 v122, v80, v81
    v_cvt_pk_bf16_f32 v123, v82, v83
    v_mfma_f32_16x16x32_bf16 v[88:91], v[172:175], v[32:35], v[88:91]
    v_cvt_pk_bf16_f32 v124, v84, v85
    v_cvt_pk_bf16_f32 v125, v86, v87
    v_mfma_f32_16x16x32_bf16 v[88:91], v[200:203], v[36:39], v[88:91]
    v_mov_b32_dpp v114, v122 row_ror:8 row_mask:0xf bank_mask:0x3
    v_mov_b32_dpp v115, v123 row_ror:8 row_mask:0xf bank_mask:0x3
    v_mfma_f32_16x16x32_bf16 v[88:91], v[244:247], v[40:43], v[88:91]
    v_mov_b32_dpp v116, v124 row_ror:8 row_mask:0xf bank_mask:0x3
    v_mov_b32_dpp v117, v125 row_ror:8 row_mask:0xf bank_mask:0x3
    v_mfma_f32_16x16x32_bf16 v[92:95], a[128:131], v[16:19], 0
    buffer_store_dwordx4 v[114:117], v4, s[32:35], s70 offen offset:0
    v_lshl_add_u32 v213, v6, 4, v213
    v_mfma_f32_16x16x32_bf16 v[92:95], a[156:159], v[20:23], v[92:95]
    v_add_u32 v213, s53, v213
    v_mfma_f32_16x16x32_bf16 v[92:95], a[184:187], v[24:27], v[92:95]
    v_mfma_f32_16x16x32_bf16 v[92:95], v[148:151], v[28:31], v[92:95]
    v_mfma_f32_16x16x32_bf16 v[92:95], v[176:179], v[32:35], v[92:95]
    v_mfma_f32_16x16x32_bf16 v[92:95], v[204:207], v[36:39], v[92:95]
    v_mfma_f32_16x16x32_bf16 v[92:95], v[248:251], v[40:43], v[92:95]
    v_mfma_f32_16x16x32_bf16 v[96:99], a[132:135], v[16:19], 0
    v_mfma_f32_16x16x32_bf16 v[96:99], a[160:163], v[20:23], v[96:99]
    v_mfma_f32_16x16x32_bf16 v[96:99], a[188:191], v[24:27], v[96:99]
    v_mfma_f32_16x16x32_bf16 v[96:99], v[152:155], v[28:31], v[96:99]
    v_cvt_pk_bf16_f32 v118, v88, v89
    v_cvt_pk_bf16_f32 v119, v90, v91
    v_mfma_f32_16x16x32_bf16 v[96:99], v[180:183], v[32:35], v[96:99]
    s_nop 0
    v_cvt_pk_bf16_f32 v120, v92, v93
    v_cvt_pk_bf16_f32 v121, v94, v95
    v_mfma_f32_16x16x32_bf16 v[96:99], v[224:227], v[36:39], v[96:99]
    v_mfma_f32_16x16x32_bf16 v[96:99], v[252:255], v[40:43], v[96:99]
    s_nop 7
    v_cvt_pk_bf16_f32 v122, v96, v97
    v_cvt_pk_bf16_f32 v123, v98, v99
    s_nop 0
    v_mov_b32_dpp v118, v122 row_ror:8 row_mask:0xf bank_mask:0x3
    v_mov_b32_dpp v119, v123 row_ror:8 row_mask:0xf bank_mask:0x3
    buffer_store_dwordx4 v[118:121], v4, s[32:35], s70 offen offset:1024
    s_cmp_eq_u32 s100, 0
    s_cbranch_scc1 L_slow6
L_back6:
    s_waitcnt vmcnt(26)
    v_mov_b32_dpp v72, v80 row_ror:8 row_mask:0xf bank_mask:0xc
    v_mov_b32_dpp v73, v81 row_ror:8 row_mask:0xf bank_mask:0xc
    v_mov_b32_dpp v74, v82 row_ror:8 row_mask:0xf bank_mask:0xc
    v_mov_b32_dpp v75, v83 row_ror:8 row_mask:0xf bank_mask:0xc
    v_mov_b32_dpp v76, v84 row_ror:8 row_mask:0xf bank_mask:0xc
    v_mov_b32_dpp v77, v85 row_ror:8 row_mask:0xf bank_mask:0xc
    v_mov_b32_dpp v78, v86 row_ror:8 row_mask:0xf bank_mask:0xc
    v_mov_b32_dpp v79, v87 row_ror:8 row_mask:0xf bank_mask:0xc
    v_mov_b32_dpp v88, v96 row_ror:8 row_mask:0xf bank_mask:0xc
    v_mov_b32_dpp v89, v97 row_ror:8 row_mask:0xf bank_mask:0xc
    v_mov_b32_dpp v90, v98 row_ror:8 row_mask:0xf bank_mask:0xc
    v_mov_b32_dpp v91, v99 row_ror:8 row_mask:0xf bank_mask:0xc
    buffer_load_dwordx4 v[144:147], v209, s[32:35], 0 offen offset:0 sc1
    buffer_load_dwordx4 v[148:151], v209, s[32:35], 0 offen offset:1024 sc1
    v_lshlrev_b32 v108, 16, v100
    v_and_b32 v109, 0xffff0000, v100
    v_lshlrev_b32 v110, 16, v101
    v_and_b32 v111, 0xffff0000, v101
    v_pk_add_f32 v[72:73], v[72:73], v[108:109]
    v_pk_add_f32 v[74:75], v[74:75], v[110:111]
    v_lshlrev_b32 v108, 16, v102
    v_and_b32 v109, 0xffff0000, v102
    v_lshlrev_b32 v110, 16, v103
    v_and_b32 v111, 0xffff0000, v103
    v_pk_add_f32 v[76:77], v[76:77], v[108:109]
    v_pk_add_f32 v[78:79], v[78:79], v[110:111]
    v_lshlrev_b32 v108, 16, v104
    v_and_b32 v109, 0xffff0000, v104
    v_lshlrev_b32 v110, 16, v105
    v_and_b32 v111, 0xffff0000, v105
    v_pk_add_f32 v[88:89], v[88:89], v[108:109]
    v_pk_add_f32 v[90:91], v[90:91], v[110:111]
    v_lshlrev_b32 v108, 16, v106
    v_and_b32 v109, 0xffff0000, v106
    v_lshlrev_b32 v110, 16, v107
    v_and_b32 v111, 0xffff0000, v107
    v_pk_add_f32 v[92:93], v[92:93], v[108:109]
    v_pk_add_f32 v[94:95], v[94:95], v[110:111]
    v_mov_b32 v32, 0
    v_mov_b32 v34, 0
    s_waitcnt vmcnt(0)
    v_max3_u32 v9, v144, v148, v144
    v_cmp_eq_u32 vcc, -1, v9
    s_nop 1
    s_cbranch_vccnz L_slow7
L_back7:
    v_lshlrev_b32 v152, 16, v144
    v_and_b32 v153, 0xffff0000, v144
    v_lshlrev_b32 v154, 16, v145
    v_and_b32 v155, 0xffff0000, v145
    v_pk_add_f32 v[72:73], v[72:73], v[152:153]
    v_pk_add_f32 v[74:75], v[74:75], v[154:155]
    v_cvt_pk_bf16_f32 v16, v72, v73
    v_cvt_pk_bf16_f32 v17, v74, v75
    ds_write_b64 v212, v[16:17] offset:0
    v_dot2_f32_bf16 v32, v16, v139, v32
    v_dot2_f32_bf16 v34, v16, v16, v34
    v_dot2_f32_bf16 v32, v17, v139, v32
    v_dot2_f32_bf16 v34, v17, v17, v34
    v_lshlrev_b32 v156, 16, v146
    v_and_b32 v157, 0xffff0000, v146
    v_lshlrev_b32 v158, 16, v147
    v_and_b32 v159, 0xffff0000, v147
    v_pk_add_f32 v[76:77], v[76:77], v[156:157]
    v_pk_add_f32 v[78:79], v[78:79], v[158:159]
    v_cvt_pk_bf16_f32 v18, v76, v77
    v_cvt_pk_bf16_f32 v19, v78, v79
    ds_write_b64 v212, v[18:19] offset:32
    v_dot2_f32_bf16 v32, v18, v139, v32
    v_dot2_f32_bf16 v34, v18, v18, v34
    v_dot2_f32_bf16 v32, v19, v139, v32
    v_dot2_f32_bf16 v34, v19, v19, v34
    v_lshlrev_b32 v152, 16, v148
    v_and_b32 v153, 0xffff0000, v148
    v_lshlrev_b32 v154, 16, v149
    v_and_b32 v155, 0xffff0000, v149
    v_pk_add_f32 v[88:89], v[88:89], v[152:153]
    v_pk_add_f32 v[90:91], v[90:91], v[154:155]
    v_cvt_pk_bf16_f32 v20, v88, v89
    v_cvt_pk_bf16_f32 v21, v90, v91
    ds_write_b64 v212, v[20:21] offset:128
    v_dot2_f32_bf16 v32, v20, v139, v32
    v_dot2_f32_bf16 v34, v20, v20, v34
    v_dot2_f32_bf16 v32, v21, v139, v32
    v_dot2_f32_bf16 v34, v21, v21, v34
    s_mov_b32 exec_lo, 16711935
    s_mov_b32 exec_hi, 16711935
    v_lshlrev_b32 v156, 16, v150
    v_and_b32 v157, 0xffff0000, v150
    v_lshlrev_b32 v158, 16, v151
    v_and_b32 v159, 0xffff0000, v151
    v_pk_add_f32 v[92:93], v[92:93], v[156:157]
    v_pk_add_f32 v[94:95], v[94:95], v[158:159]
    v_cvt_pk_bf16_f32 v22, v92, v93
    v_cvt_pk_bf16_f32 v23, v94, v95
    ds_write_b64 v212, v[22:23] offset:160
    v_dot2_f32_bf16 v32, v22, v139, v32
    v_dot2_f32_bf16 v34, v22, v22, v34
    v_dot2_f32_bf16 v32, v23, v139, v32
    v_dot2_f32_bf16 v34, v23, v23, v34
    s_mov_b64 exec, -1
    s_nop 0
    v_add_f32_dpp v32, v32, v32 row_ror:8 row_mask:0xf bank_mask:0xf
    v_add_f32_dpp v34, v34, v34 row_ror:8 row_mask:0xf bank_mask:0xf
    v_mov_b32 v33, v32
    v_mov_b32 v35, v34
    s_nop 0
    v_permlane16_swap_b32 v32, v33
    v_permlane16_swap_b32 v34, v35
    v_add_f32 v32, v32, v33
    v_add_f32 v34, v34, v35
    v_mov_b32 v33, v32
    v_mov_b32 v35, v34
    s_nop 0
    v_permlane32_swap_b32 v32, v33
    v_permlane32_swap_b32 v34, v35
    v_add_f32 v32, v32, v33
    v_add_f32 v33, v34, v35
    s_mov_b64 exec, 0xff
    ds_write_b64 v221, v[32:33]
    s_mov_b64 exec, -1
    s_waitcnt lgkmcnt(0)
    s_barrier
    ds_read_b128 v[16:19], v213
    ds_read_b128 v[20:23], v213 offset:128
    ds_read_b64 v[24:25], v220 offset:0
    ds_read_b64 v[26:27], v220 offset:64
    ds_read_b64 v[28:29], v220 offset:128
    ds_read_b64 v[30:31], v220 offset:192
    s_waitcnt lgkmcnt(4)
    v_lshlrev_b32 v144, 16, v16
    v_and_b32 v145, 0xffff0000, v16
    v_lshlrev_b32 v146, 16, v17
    v_and_b32 v147, 0xffff0000, v17
    v_lshlrev_b32 v148, 16, v18
    v_and_b32 v149, 0xffff0000, v18
    v_lshlrev_b32 v150, 16, v19
    v_and_b32 v151, 0xffff0000, v19
    v_lshlrev_b32 v152, 16, v20
    v_and_b32 v153, 0xffff0000, v20
    v_lshlrev_b32 v154, 16, v21
    v_and_b32 v155, 0xffff0000, v21
    v_lshlrev_b32 v156, 16, v22
    v_and_b32 v157, 0xffff0000, v22
    v_lshlrev_b32 v158, 16, v23
    v_and_b32 v159, 0xffff0000, v23
    s_waitcnt lgkmcnt(0)
    v_pk_add_f32 v[24:25], v[24:25], v[26:27]
    v_pk_add_f32 v[28:29], v[28:29], v[30:31]
    v_pk_add_f32 v[24:25], v[24:25], v[28:29]
    v_mul_f32 v24, 0x3b124925, v24
    v_mul_f32 v25, 0x3b124925, v25
    v_fma_f32 v25, -v24, v24, v25
    v_max_f32 v25, 0, v25
    v_cvt_pk_bf16_f32 v25, v25, v25
    v_lshlrev_b32 v25, 16, v25
    v_add_f32 v25, 0x3727c5ac, v25
    v_cvt_pk_bf16_f32 v25, v25, v25
    v_lshlrev_b32 v25, 16, v25
    v_sqrt_f32 v25, v25
    v_cvt_pk_bf16_f32 v24, v24, v24
    v_lshlrev_b32 v24, 16, v24
    v_cvt_pk_bf16_f32 v25, v25, v25
    v_lshlrev_b32 v25, 16, v25
    v_rcp_f32 v26, v25
    v_mov_b32 v30, s101
    v_cmp_gt_u32 vcc, 8, v1
    s_nop 1
    v_cndmask_b32 v30, v30, v216, vcc
    v_mul_f32 v28, -v24, v26
    v_pk_fma_f32 v[144:145], v[144:145], v[26:27], v[28:29] op_sel_hi:[1,0,0]
    v_pk_fma_f32 v[146:147], v[146:147], v[26:27], v[28:29] op_sel_hi:[1,0,0]
    v_pk_fma_f32 v[148:149], v[148:149], v[26:27], v[28:29] op_sel_hi:[1,0,0]
    v_pk_fma_f32 v[150:151], v[150:151], v[26:27], v[28:29] op_sel_hi:[1,0,0]
    v_cvt_pk_bf16_f32 v32, v144, v145
    v_cvt_pk_bf16_f32 v33, v146, v147
    v_cvt_pk_bf16_f32 v34, v148, v149
    v_cvt_pk_bf16_f32 v35, v150, v151
    buffer_store_dwordx4 v[32:35], v216, s[32:35], s65 offen offset:0
    v_pk_fma_f32 v[152:153], v[152:153], v[26:27], v[28:29] op_sel_hi:[1,0,0]
    v_pk_fma_f32 v[154:155], v[154:155], v[26:27], v[28:29] op_sel_hi:[1,0,0]
    v_pk_fma_f32 v[156:157], v[156:157], v[26:27], v[28:29] op_sel_hi:[1,0,0]
    v_pk_fma_f32 v[158:159], v[158:159], v[26:27], v[28:29] op_sel_hi:[1,0,0]
    v_cvt_pk_bf16_f32 v36, v152, v153
    v_cvt_pk_bf16_f32 v37, v154, v155
    v_cvt_pk_bf16_f32 v38, v156, v157
    v_cvt_pk_bf16_f32 v39, v158, v159
    buffer_store_dwordx4 v[36:39], v217, s[32:35], s65 offen offset:2048
    buffer_store_dwordx2 v[24:25], v30, s[32:35], s61 offen
    s_cmp_eq_u32 s100, 0
    s_cbranch_scc1 L_slow8
L_back8:
    s_branch L_pg3
.p2align 12
L_pg3:
    ds_read_b128 a[224:227], v130 offset:0
    ds_read_b128 a[228:231], v130 offset:1024
    ds_read_b128 a[232:235], v130 offset:2048
    ds_read_b128 a[236:239], v130 offset:3072
    ds_read_b128 a[240:243], v130 offset:4096
    ds_read_b128 a[244:247], v130 offset:5120
    ds_read_b128 a[248:251], v130 offset:6144
    s_barrier
    v_mov_b32 v140, 0xbdd2d3e8
    v_mov_b32 v141, 0xc0135761
    v_and_b32 v128, 1, v3
    v_lshlrev_b32 v128, 9, v128
    buffer_load_dwordx4 v[144:147], v4, s[32:35], s78 offen sc1
    buffer_load_dwordx4 v[148:151], v132, s[32:35], s78 offen sc1
    buffer_load_dwordx4 v[152:155], v4, s[32:35], s79 offen sc1
    buffer_load_dwordx4 v[156:159], v132, s[32:35], s79 offen sc1
    buffer_load_dwordx4 v[160:163], v4, s[32:35], s80 offen sc1
    buffer_load_dwordx4 v[164:167], v132, s[32:35], s80 offen sc1
    buffer_load_dwordx4 v[168:171], v4, s[32:35], s81 offen sc1
    buffer_load_dwordx4 v[172:175], v132, s[32:35], s81 offen sc1
    buffer_load_dwordx4 v[176:179], v4, s[32:35], s82 offen sc1
    buffer_load_dwordx4 v[180:183], v132, s[32:35], s82 offen sc1
    v_mul_u32_u24_dpp v44, v214, v137 row_newbcast:0 row_mask:0xf bank_mask:0xf
    v_and_b32_dpp v45, v214, v136 row_newbcast:0 row_mask:0xf bank_mask:0xf
    v_mul_u32_u24_dpp v46, v215, v137 row_newbcast:0 row_mask:0xf bank_mask:0xf
    v_and_b32_dpp v47, v215, v136 row_newbcast:0 row_mask:0xf bank_mask:0xf
    v_mul_u32_u24_dpp v48, v214, v137 row_newbcast:1 row_mask:0xf bank_mask:0xf
    v_and_b32_dpp v49, v214, v136 row_newbcast:1 row_mask:0xf bank_mask:0xf
    v_mul_u32_u24_dpp v50, v215, v137 row_newbcast:1 row_mask:0xf bank_mask:0xf
    v_and_b32_dpp v51, v215, v136 row_newbcast:1 row_mask:0xf bank_mask:0xf
    v_mul_u32_u24_dpp v52, v214, v137 row_newbcast:2 row_mask:0xf bank_mask:0xf
    v_and_b32_dpp v53, v214, v136 row_newbcast:2 row_mask:0xf bank_mask:0xf
    v_mul_u32_u24_dpp v54, v215, v137 row_newbcast:2 row_mask:0xf bank_mask:0xf
    v_and_b32_dpp v55, v215, v136 row_newbcast:2 row_mask:0xf bank_mask:0xf
    v_mul_u32_u24_dpp v56, v214, v137 row_newbcast:3 row_mask:0xf bank_mask:0xf
    v_and_b32_dpp v57, v214, v136 row_newbcast:3 row_mask:0xf bank_mask:0xf
    v_mul_u32_u24_dpp v58, v215, v137 row_newbcast:3 row_mask:0xf bank_mask:0xf
    v_and_b32_dpp v59, v215, v136 row_newbcast:3 row_mask:0xf bank_mask:0xf
    v_mul_u32_u24_dpp v60, v214, v137 row_newbcast:4 row_mask:0xf bank_mask:0xf
    v_and_b32_dpp v61, v214, v136 row_newbcast:4 row_mask:0xf bank_mask:0xf
    v_mul_u32_u24_dpp v62, v215, v137 row_newbcast:4 row_mask:0xf bank_mask:0xf
    v_and_b32_dpp v63, v215, v136 row_newbcast:4 row_mask:0xf bank_mask:0xf
    v_mul_u32_u24_dpp v64, v214, v137 row_newbcast:5 row_mask:0xf bank_mask:0xf
    v_and_b32_dpp v65, v214, v136 row_newbcast:5 row_mask:0xf bank_mask:0xf
    v_mul_u32_u24_dpp v66, v215, v137 row_newbcast:5 row_mask:0xf bank_mask:0xf
    v_and_b32_dpp v67, v215, v136 row_newbcast:5 row_mask:0xf bank_mask:0xf
    v_mul_u32_u24_dpp v68, v214, v137 row_newbcast:6 row_mask:0xf bank_mask:0xf
    v_and_b32_dpp v69, v214, v136 row_newbcast:6 row_mask:0xf bank_mask:0xf
    v_mul_u32_u24_dpp v70, v215, v137 row_newbcast:6 row_mask:0xf bank_mask:0xf
    v_and_b32_dpp v71, v215, v136 row_newbcast:6 row_mask:0xf bank_mask:0xf
    v_lshrrev_b32 v129, 1, v3
    v_lshl_add_u32 v128, v129, 8, v128
    v_lshl_add_u32 v128, v2, 4, v128
    v_add_u32 v129, 4096, v128
    s_lshl_b32 s70, s48, 2
    s_add_u32 s70, s70, s8
    s_and_b32 s72, s30, 1
    s_lshr_b32 s52, s30, 1
    s_waitcnt vmcnt(6)
    v_max3_u32 v9, v144, v148, v152
    v_max3_u32 v9, v9, v156, v156
    v_cmp_eq_u32 vcc, -1, v9
    s_nop 1
    s_cbranch_vccnz L_slow9
L_back9:
    s_waitcnt lgkmcnt(5)
    v_mfma_f32_16x16x32_bf16 v[72:75], a[224:227], v[144:147], v[44:47]
    ds_read_b128 v[16:19], v130 offset:7168
    v_mfma_f32_16x16x32_bf16 v[100:103], a[224:227], v[148:151], v[44:47]
    buffer_load_dwordx4 v[184:187], v4, s[32:35], s83 offen sc1
    v_mfma_f32_16x16x32_bf16 v[76:79], a[228:231], v[144:147], v[48:51]
    ds_read_b128 v[20:23], v130 offset:8192
    v_mfma_f32_16x16x32_bf16 v[104:107], a[228:231], v[148:151], v[48:51]
    s_waitcnt lgkmcnt(5)
    v_mfma_f32_16x16x32_bf16 v[80:83], a[232:235], v[144:147], v[52:55]
    ds_read_b128 v[24:27], v130 offset:9216
    v_mfma_f32_16x16x32_bf16 v[108:111], a[232:235], v[148:151], v[52:55]
    buffer_load_dwordx4 v[188:191], v132, s[32:35], s83 offen sc1
    v_mfma_f32_16x16x32_bf16 v[84:87], a[236:239], v[144:147], v[56:59]
    ds_read_b128 v[28:31], v130 offset:10240
    v_mfma_f32_16x16x32_bf16 v[112:115], a[236:239], v[148:151], v[56:59]
    s_waitcnt lgkmcnt(5)
    v_mfma_f32_16x16x32_bf16 v[88:91], a[240:243], v[144:147], v[60:63]
    ds_read_b128 v[32:35], v130 offset:11264
    v_mfma_f32_16x16x32_bf16 v[116:119], a[240:243], v[148:151], v[60:63]
    buffer_load_dwordx4 v[192:195], v4, s[32:35], s84 offen sc1
    v_mfma_f32_16x16x32_bf16 v[92:95], a[244:247], v[144:147], v[64:67]
    ds_read_b128 v[36:39], v130 offset:12288
    v_mfma_f32_16x16x32_bf16 v[120:123], a[244:247], v[148:151], v[64:67]
    s_waitcnt lgkmcnt(5)
    v_mfma_f32_16x16x32_bf16 v[96:99], a[248:251], v[144:147], v[68:71]
    ds_read_b128 v[40:43], v130 offset:13312
    v_mfma_f32_16x16x32_bf16 v[124:127], a[248:251], v[148:151], v[68:71]
    buffer_load_dwordx4 v[196:199], v132, s[32:35], s84 offen sc1
    v_mfma_f32_16x16x32_bf16 v[72:75], v[16:19], v[152:155], v[72:75]
    ds_read_b128 a[224:227], v130 offset:14336
    v_mfma_f32_16x16x32_bf16 v[100:103], v[16:19], v[156:159], v[100:103]
    s_lshl_b32 s71, s9, 1
    s_waitcnt lgkmcnt(5)
    v_mfma_f32_16x16x32_bf16 v[76:79], v[20:23], v[152:155], v[76:79]
    ds_read_b128 a[228:231], v130 offset:15360
    v_mfma_f32_16x16x32_bf16 v[104:107], v[20:23], v[156:159], v[104:107]
    buffer_load_dwordx4 v[200:203], v4, s[32:35], s85 offen sc1
    v_mfma_f32_16x16x32_bf16 v[80:83], v[24:27], v[152:155], v[80:83]
    ds_read_b128 a[232:235], v130 offset:16384
    v_mfma_f32_16x16x32_bf16 v[108:111], v[24:27], v[156:159], v[108:111]
    s_add_u32 s71, s71, s52
    s_waitcnt lgkmcnt(5)
    v_mfma_f32_16x16x32_bf16 v[84:87], v[28:31], v[152:155], v[84:87]
    ds_read_b128 a[236:239], v130 offset:17408
    v_mfma_f32_16x16x32_bf16 v[112:115], v[28:31], v[156:159], v[112:115]
    buffer_load_dwordx4 v[204:207], v132, s[32:35], s85 offen sc1
    v_mfma_f32_16x16x32_bf16 v[88:91], v[32:35], v[152:155], v[88:91]
    ds_read_b128 a[240:243], v130 offset:18432
    v_mfma_f32_16x16x32_bf16 v[116:119], v[32:35], v[156:159], v[116:119]
    s_lshl_b32 s71, s71, 5
    s_waitcnt vmcnt(6)
    v_max3_u32 v9, v160, v164, v168
    v_max3_u32 v9, v9, v172, v176
    v_max3_u32 v9, v9, v180, v180
    v_cmp_eq_u32 vcc, -1, v9
    s_nop 1
    s_cbranch_vccnz L_slow10
L_back10:
    s_waitcnt lgkmcnt(5)
    v_mfma_f32_16x16x32_bf16 v[92:95], v[36:39], v[152:155], v[92:95]
    ds_read_b128 a[244:247], v130 offset:19456
    v_mfma_f32_16x16x32_bf16 v[120:123], v[36:39], v[156:159], v[120:123]
    buffer_load_dwordx4 v[208:211], v4, s[32:35], s86 offen sc1
    v_mfma_f32_16x16x32_bf16 v[96:99], v[40:43], v[152:155], v[96:99]
    ds_read_b128 a[248:251], v130 offset:20480
    v_mfma_f32_16x16x32_bf16 v[124:127], v[40:43], v[156:159], v[124:127]
    s_mul_i32 s53, s72, 114688
    s_waitcnt lgkmcnt(5)
    v_mfma_f32_16x16x32_bf16 v[72:75], a[224:227], v[160:163], v[72:75]
    ds_read_b128 v[16:19], v130 offset:21504
    v_mfma_f32_16x16x32_bf16 v[100:103], a[224:227], v[164:167], v[100:103]
    buffer_load_dwordx4 v[212:215], v132, s[32:35], s86 offen sc1
    v_mfma_f32_16x16x32_bf16 v[76:79], a[228:231], v[160:163], v[76:79]
    ds_read_b128 v[20:23], v130 offset:22528
    v_mfma_f32_16x16x32_bf16 v[104:107], a[228:231], v[164:167], v[104:107]
    s_sub_u32 s54, 114688, s53
    s_waitcnt lgkmcnt(5)
    v_mfma_f32_16x16x32_bf16 v[80:83], a[232:235], v[160:163], v[80:83]
    ds_read_b128 v[24:27], v130 offset:23552
    v_mfma_f32_16x16x32_bf16 v[108:111], a[232:235], v[164:167], v[108:111]
    buffer_load_dwordx4 v[216:219], v4, s[32:35], s87 offen sc1
    v_mfma_f32_16x16x32_bf16 v[84:87], a[236:239], v[160:163], v[84:87]
    ds_read_b128 v[28:31], v130 offset:24576
    v_mfma_f32_16x16x32_bf16 v[112:115], a[236:239], v[164:167], v[112:115]
    v_add_u32 v142, s53, v4
    s_waitcnt lgkmcnt(5)
    v_mfma_f32_16x16x32_bf16 v[88:91], a[240:243], v[160:163], v[88:91]
    ds_read_b128 v[32:35], v130 offset:25600
    v_mfma_f32_16x16x32_bf16 v[116:119], a[240:243], v[164:167], v[116:119]
    buffer_load_dwordx4 v[220:223], v132, s[32:35], s87 offen sc1
    v_mfma_f32_16x16x32_bf16 v[92:95], a[244:247], v[160:163], v[92:95]
    ds_read_b128 v[36:39], v130 offset:26624
    v_mfma_f32_16x16x32_bf16 v[120:123], a[244:247], v[164:167], v[120:123]
    v_add_u32 v143, s54, v4
    s_waitcnt lgkmcnt(5)
    v_mfma_f32_16x16x32_bf16 v[96:99], a[248:251], v[160:163], v[96:99]
    ds_read_b128 v[40:43], v130 offset:27648
    v_mfma_f32_16x16x32_bf16 v[124:127], a[248:251], v[164:167], v[124:127]
    buffer_load_dwordx4 v[224:227], v4, s[32:35], s88 offen sc1
    v_mfma_f32_16x16x32_bf16 v[72:75], v[16:19], v[168:171], v[72:75]
    ds_read_b128 a[224:227], v130 offset:28672
    v_mfma_f32_16x16x32_bf16 v[100:103], v[16:19], v[172:175], v[100:103]
    s_mul_i32 s56, s70, 224
    s_waitcnt lgkmcnt(5)
    v_mfma_f32_16x16x32_bf16 v[76:79], v[20:23], v[168:171], v[76:79]
    ds_read_b128 a[228:231], v130 offset:29696
    v_mfma_f32_16x16x32_bf16 v[104:107], v[20:23], v[172:175], v[104:107]
    buffer_load_dwordx4 v[228:231], v132, s[32:35], s88 offen sc1
    v_mfma_f32_16x16x32_bf16 v[80:83], v[24:27], v[168:171], v[80:83]
    ds_read_b128 a[232:235], v130 offset:30720
    v_mfma_f32_16x16x32_bf16 v[108:111], v[24:27], v[172:175], v[108:111]
    s_mul_i32 s53, s30, 28
    s_waitcnt lgkmcnt(5)
    v_mfma_f32_16x16x32_bf16 v[84:87], v[28:31], v[168:171], v[84:87]
    ds_read_b128 a[236:239], v130 offset:31744
    v_mfma_f32_16x16x32_bf16 v[112:115], v[28:31], v[172:175], v[112:115]
    buffer_load_dwordx4 v[232:235], v4, s[32:35], s89 offen sc1
    v_mfma_f32_16x16x32_bf16 v[88:91], v[32:35], v[168:171], v[88:91]
    ds_read_b128 a[240:243], v130 offset:32768
    v_mfma_f32_16x16x32_bf16 v[116:119], v[32:35], v[172:175], v[116:119]
    s_add_u32 s56, s56, s53
    s_waitcnt lgkmcnt(5)
    v_mfma_f32_16x16x32_bf16 v[92:95], v[36:39], v[168:171], v[92:95]
    ds_read_b128 a[244:247], v130 offset:33792
    v_mfma_f32_16x16x32_bf16 v[120:123], v[36:39], v[172:175], v[120:123]
    buffer_load_dwordx4 v[236:239], v132, s[32:35], s89 offen sc1
    v_mfma_f32_16x16x32_bf16 v[96:99], v[40:43], v[168:171], v[96:99]
    ds_read_b128 a[248:251], v130 offset:34816
    v_mfma_f32_16x16x32_bf16 v[124:127], v[40:43], v[172:175], v[124:127]
    s_lshl_b32 s56, s56, 10
    s_waitcnt lgkmcnt(5)
    v_mfma_f32_16x16x32_bf16 v[72:75], a[224:227], v[176:179], v[72:75]
    ds_read_b128 v[16:19], v130 offset:35840
    v_mfma_f32_16x16x32_bf16 v[100:103], a[224:227], v[180:183], v[100:103]
    buffer_load_dwordx4 v[240:243], v4, s[32:35], s90 offen sc1
    v_mfma_f32_16x16x32_bf16 v[76:79], a[228:231], v[176:179], v[76:79]
    ds_read_b128 v[20:23], v130 offset:36864
    v_mfma_f32_16x16x32_bf16 v[104:107], a[228:231], v[180:183], v[104:107]
    s_add_u32 s56, s56, 7995392
    s_waitcnt lgkmcnt(5)
    v_mfma_f32_16x16x32_bf16 v[80:83], a[232:235], v[176:179], v[80:83]
    ds_read_b128 v[24:27], v130 offset:37888
    v_mfma_f32_16x16x32_bf16 v[108:111], a[232:235], v[180:183], v[108:111]
    buffer_load_dwordx4 v[244:247], v132, s[32:35], s90 offen sc1
    v_mfma_f32_16x16x32_bf16 v[84:87], a[236:239], v[176:179], v[84:87]
    ds_read_b128 v[28:31], v130 offset:38912
    v_mfma_f32_16x16x32_bf16 v[112:115], a[236:239], v[180:183], v[112:115]
    s_cmp_ge_u32 s49, 28
    s_cselect_b32 s56, s101, s56
    s_waitcnt lgkmcnt(5)
    v_mfma_f32_16x16x32_bf16 v[88:91], a[240:243], v[176:179], v[88:91]
    ds_read_b128 v[32:35], v130 offset:39936
    v_mfma_f32_16x16x32_bf16 v[116:119], a[240:243], v[180:183], v[116:119]
    buffer_load_dwordx4 v[248:251], v4, s[32:35], s91 offen sc1
    s_waitcnt vmcnt(9)
    v_max3_u32 v9, v184, v188, v192
    v_max3_u32 v9, v9, v196, v200
    v_max3_u32 v9, v9, v204, v208
    v_max3_u32 v9, v9, v212, v212
    v_cmp_eq_u32 vcc, -1, v9
    s_nop 1
    s_cbranch_vccnz L_slow11
L_back11:
    v_mfma_f32_16x16x32_bf16 v[92:95], a[244:247], v[176:179], v[92:95]
    ds_read_b128 v[36:39], v130 offset:40960
    v_mfma_f32_16x16x32_bf16 v[120:123], a[244:247], v[180:183], v[120:123]
    s_add_u32 s66, s56, 0
    s_waitcnt lgkmcnt(5)
    v_mfma_f32_16x16x32_bf16 v[96:99], a[248:251], v[176:179], v[96:99]
    ds_read_b128 v[40:43], v130 offset:41984
    v_mfma_f32_16x16x32_bf16 v[124:127], a[248:251], v[180:183], v[124:127]
    buffer_load_dwordx4 v[252:255], v132, s[32:35], s91 offen sc1
    v_mfma_f32_16x16x32_bf16 v[72:75], v[16:19], v[184:187], v[72:75]
    ds_read_b128 a[224:227], v130 offset:43008
    v_mfma_f32_16x16x32_bf16 v[100:103], v[16:19], v[188:191], v[100:103]
    s_add_u32 s67, s56, 7168
    s_waitcnt lgkmcnt(5)
    v_mfma_f32_16x16x32_bf16 v[76:79], v[20:23], v[184:187], v[76:79]
    ds_read_b128 a[228:231], v130 offset:44032
    v_mfma_f32_16x16x32_bf16 v[104:107], v[20:23], v[188:191], v[104:107]
    buffer_load_dwordx4 a[108:111], v8, s[32:35], s12 offen sc1
    v_mfma_f32_16x16x32_bf16 v[80:83], v[24:27], v[184:187], v[80:83]
    ds_read_b128 a[232:235], v130 offset:45056
    v_mfma_f32_16x16x32_bf16 v[108:111], v[24:27], v[188:191], v[108:111]
    s_add_u32 s68, s56, 14336
    s_waitcnt lgkmcnt(5)
    v_mfma_f32_16x16x32_bf16 v[84:87], v[28:31], v[184:187], v[84:87]
    ds_read_b128 a[236:239], v130 offset:46080
    v_mfma_f32_16x16x32_bf16 v[112:115], v[28:31], v[188:191], v[112:115]
    s_add_u32 s12, s59, 6144
    buffer_load_dwordx4 a[112:115], v7, s[32:35], s12 offen sc1
    v_mfma_f32_16x16x32_bf16 v[88:91], v[32:35], v[184:187], v[88:91]
    ds_read_b128 a[240:243], v130 offset:47104
    v_mfma_f32_16x16x32_bf16 v[116:119], v[32:35], v[188:191], v[116:119]
    s_add_u32 s69, s56, 21504
    s_waitcnt lgkmcnt(5)
    v_mfma_f32_16x16x32_bf16 v[92:95], v[36:39], v[184:187], v[92:95]
    ds_read_b128 a[244:247], v130 offset:48128
    v_mfma_f32_16x16x32_bf16 v[120:123], v[36:39], v[188:191], v[120:123]
    buffer_load_dwordx4 a[116:119], v8, s[32:35], s12 offen sc1
    v_mfma_f32_16x16x32_bf16 v[96:99], v[40:43], v[184:187], v[96:99]
    ds_read_b128 a[248:251], v130 offset:49152
    v_mfma_f32_16x16x32_bf16 v[124:127], v[40:43], v[188:191], v[124:127]
    v_add_u32 v6, 4096, v142
    s_waitcnt lgkmcnt(5)
    v_mfma_f32_16x16x32_bf16 v[72:75], a[224:227], v[192:195], v[72:75]
    ds_read_b128 v[16:19], v130 offset:50176
    v_mfma_f32_16x16x32_bf16 v[100:103], a[224:227], v[196:199], v[100:103]
    s_add_u32 s12, s26, 6144
    buffer_load_dwordx4 a[120:123], v7, s[32:35], s12 offen sc1
    v_mfma_f32_16x16x32_bf16 v[76:79], a[228:231], v[192:195], v[76:79]
    ds_read_b128 v[20:23], v130 offset:51200
    v_mfma_f32_16x16x32_bf16 v[104:107], a[228:231], v[196:199], v[104:107]
    v_add_u32 v10, 4096, v143
    s_waitcnt lgkmcnt(5)
    v_mfma_f32_16x16x32_bf16 v[80:83], a[232:235], v[192:195], v[80:83]
    ds_read_b128 v[24:27], v130 offset:52224
    v_mfma_f32_16x16x32_bf16 v[108:111], a[232:235], v[196:199], v[108:111]
    buffer_load_dwordx4 a[124:127], v8, s[32:35], s12 offen sc1
    v_mfma_f32_16x16x32_bf16 v[84:87], a[236:239], v[192:195], v[84:87]
    ds_read_b128 v[28:31], v130 offset:53248
    v_mfma_f32_16x16x32_bf16 v[112:115], a[236:239], v[196:199], v[112:115]
    v_lshrrev_b32 v5, 1, v3
    s_waitcnt lgkmcnt(5)
    v_mfma_f32_16x16x32_bf16 v[88:91], a[240:243], v[192:195], v[88:91]
    ds_read_b128 v[32:35], v130 offset:54272
    v_mfma_f32_16x16x32_bf16 v[116:119], a[240:243], v[196:199], v[116:119]
    s_add_u32 s12, s11, 8192
    buffer_load_dwordx4 a[128:131], v7, s[32:35], s12 offen sc1
    v_mfma_f32_16x16x32_bf16 v[92:95], a[244:247], v[192:195], v[92:95]
    ds_read_b128 v[36:39], v130 offset:55296
    v_mfma_f32_16x16x32_bf16 v[120:123], a[244:247], v[196:199], v[120:123]
    s_lshl_b32 s55, s71, 1
    s_waitcnt lgkmcnt(5)
    v_mfma_f32_16x16x32_bf16 v[96:99], a[248:251], v[192:195], v[96:99]
    ds_read_b128 v[40:43], v130 offset:56320
    v_mfma_f32_16x16x32_bf16 v[124:127], a[248:251], v[196:199], v[124:127]
    buffer_load_dwordx4 a[132:135], v8, s[32:35], s12 offen sc1
    v_mfma_f32_16x16x32_bf16 v[72:75], v[16:19], v[200:203], v[72:75]
    ds_read_b128 a[224:227], v131 offset:0
    v_mfma_f32_16x16x32_bf16 v[100:103], v[16:19], v[204:207], v[100:103]
    s_lshl_b32 s53, s70, 1
    s_waitcnt lgkmcnt(5)
    v_mfma_f32_16x16x32_bf16 v[76:79], v[20:23], v[200:203], v[76:79]
    ds_read_b128 a[228:231], v131 offset:1024
    v_mfma_f32_16x16x32_bf16 v[104:107], v[20:23], v[204:207], v[104:107]
    s_add_u32 s12, s58, 8192
    buffer_load_dwordx4 a[136:139], v7, s[32:35], s12 offen sc1
    v_mfma_f32_16x16x32_bf16 v[80:83], v[24:27], v[200:203], v[80:83]
    ds_read_b128 a[232:235], v131 offset:2048
    v_mfma_f32_16x16x32_bf16 v[108:111], v[24:27], v[204:207], v[108:111]
    s_add_u32 s53, s53, s72
    s_waitcnt lgkmcnt(5)
    v_mfma_f32_16x16x32_bf16 v[84:87], v[28:31], v[200:203], v[84:87]
    ds_read_b128 a[236:239], v131 offset:3072
    v_mfma_f32_16x16x32_bf16 v[112:115], v[28:31], v[204:207], v[112:115]
    buffer_load_dwordx4 a[140:143], v8, s[32:35], s12 offen sc1
    v_mfma_f32_16x16x32_bf16 v[88:91], v[32:35], v[200:203], v[88:91]
    ds_read_b128 a[240:243], v131 offset:4096
    v_mfma_f32_16x16x32_bf16 v[116:119], v[32:35], v[204:207], v[116:119]
    s_mul_i32 s73, s53, 28672
    s_waitcnt lgkmcnt(5)
    v_mfma_f32_16x16x32_bf16 v[92:95], v[36:39], v[200:203], v[92:95]
    ds_read_b128 a[244:247], v131 offset:5120
    v_mfma_f32_16x16x32_bf16 v[120:123], v[36:39], v[204:207], v[120:123]
    s_add_u32 s12, s59, 8192
    buffer_load_dwordx4 a[144:147], v7, s[32:35], s12 offen sc1
    v_mfma_f32_16x16x32_bf16 v[96:99], v[40:43], v[200:203], v[96:99]
    ds_read_b128 a[248:251], v131 offset:6144
    v_mfma_f32_16x16x32_bf16 v[124:127], v[40:43], v[204:207], v[124:127]
    s_lshl_b32 s52, s71, 5
    s_waitcnt lgkmcnt(5)
    v_mfma_f32_16x16x32_bf16 v[72:75], a[224:227], v[208:211], v[72:75]
    ds_read_b128 v[16:19], v131 offset:7168
    v_mfma_f32_16x16x32_bf16 v[100:103], a[224:227], v[212:215], v[100:103]
    buffer_load_dwordx4 a[148:151], v8, s[32:35], s12 offen sc1
    v_mfma_f32_16x16x32_bf16 v[76:79], a[228:231], v[208:211], v[76:79]
    ds_read_b128 v[20:23], v131 offset:8192
    v_mfma_f32_16x16x32_bf16 v[104:107], a[228:231], v[212:215], v[104:107]
    s_add_u32 s62, s73, 6160384
    s_waitcnt lgkmcnt(5)
    v_mfma_f32_16x16x32_bf16 v[80:83], a[232:235], v[208:211], v[80:83]
    ds_read_b128 v[24:27], v131 offset:9216
    v_mfma_f32_16x16x32_bf16 v[108:111], a[232:235], v[212:215], v[108:111]
    s_add_u32 s12, s26, 8192
    buffer_load_dwordx4 a[152:155], v7, s[32:35], s12 offen sc1
    v_mfma_f32_16x16x32_bf16 v[84:87], a[236:239], v[208:211], v[84:87]
    ds_read_b128 v[28:31], v131 offset:10240
    v_mfma_f32_16x16x32_bf16 v[112:115], a[236:239], v[212:215], v[112:115]
    s_add_u32 s73, s73, s52
    s_waitcnt lgkmcnt(5)
    v_mfma_f32_16x16x32_bf16 v[88:91], a[240:243], v[208:211], v[88:91]
    ds_read_b128 v[32:35], v131 offset:11264
    v_mfma_f32_16x16x32_bf16 v[116:119], a[240:243], v[212:215], v[116:119]
    buffer_load_dwordx4 a[156:159], v8, s[32:35], s12 offen sc1
    s_waitcnt vmcnt(13)
    v_max3_u32 v9, v216, v220, v224
    v_max3_u32 v9, v9, v228, v232
    v_max3_u32 v9, v9, v236, v240
    v_max3_u32 v9, v9, v244, v248
    v_max3_u32 v9, v9, v252, v252
    v_cmp_eq_u32 vcc, -1, v9
    s_nop 1
    s_cbranch_vccnz L_slow12
L_back12:
    v_mfma_f32_16x16x32_bf16 v[92:95], a[244:247], v[208:211], v[92:95]
    ds_read_b128 v[36:39], v131 offset:12288
    v_mfma_f32_16x16x32_bf16 v[120:123], a[244:247], v[212:215], v[120:123]
    s_add_u32 s73, s73, 4325376
    s_waitcnt lgkmcnt(5)
    v_mfma_f32_16x16x32_bf16 v[96:99], a[248:251], v[208:211], v[96:99]
    ds_read_b128 v[40:43], v131 offset:13312
    v_mfma_f32_16x16x32_bf16 v[124:127], a[248:251], v[212:215], v[124:127]
    s_add_u32 s12, s11, 10240
    buffer_load_dwordx4 a[160:163], v7, s[32:35], s12 offen sc1
    v_mfma_f32_16x16x32_bf16 v[72:75], v[16:19], v[216:219], v[72:75]
    ds_read_b128 a[224:227], v131 offset:14336
    v_mfma_f32_16x16x32_bf16 v[100:103], v[16:19], v[220:223], v[100:103]
    v_and_b32 v15, 1, v3
    s_waitcnt lgkmcnt(5)
    v_mfma_f32_16x16x32_bf16 v[76:79], v[20:23], v[216:219], v[76:79]
    ds_read_b128 a[228:231], v131 offset:21504
    v_mfma_f32_16x16x32_bf16 v[104:107], v[20:23], v[220:223], v[104:107]
    buffer_load_dwordx4 a[164:167], v8, s[32:35], s12 offen sc1
    v_mfma_f32_16x16x32_bf16 v[80:83], v[24:27], v[216:219], v[80:83]
    ds_read_b128 a[232:235], v131 offset:28672
    v_mfma_f32_16x16x32_bf16 v[108:111], v[24:27], v[220:223], v[108:111]
    v_mul_u32_u24 v15, 14336, v15
    s_waitcnt lgkmcnt(5)
    v_mfma_f32_16x16x32_bf16 v[84:87], v[28:31], v[216:219], v[84:87]
    ds_read_b128 a[236:239], v131 offset:35840
    v_mfma_f32_16x16x32_bf16 v[112:115], v[28:31], v[220:223], v[112:115]
    s_add_u32 s12, s58, 10240
    buffer_load_dwordx4 a[168:171], v7, s[32:35], s12 offen sc1
    v_mfma_f32_16x16x32_bf16 v[88:91], v[32:35], v[216:219], v[88:91]
    ds_read_b128 a[240:243], v131 offset:15360
    v_mfma_f32_16x16x32_bf16 v[116:119], v[32:35], v[220:223], v[116:119]
    v_lshl_add_u32 v15, v2, 4, v15
    s_waitcnt lgkmcnt(5)
    v_mfma_f32_16x16x32_bf16 v[92:95], v[36:39], v[216:219], v[92:95]
    ds_read_b128 a[244:247], v131 offset:22528
    v_mfma_f32_16x16x32_bf16 v[120:123], v[36:39], v[220:223], v[120:123]
    buffer_load_dwordx4 a[172:175], v8, s[32:35], s12 offen sc1
    v_mfma_f32_16x16x32_bf16 v[96:99], v[40:43], v[216:219], v[96:99]
    ds_read_b128 a[248:251], v131 offset:29696
    v_mfma_f32_16x16x32_bf16 v[124:127], v[40:43], v[220:223], v[124:127]
    v_mov_b32 v2, v15
    v_lshl_add_u32 v15, v5, 8, v15
    s_mul_i32 s53, s53, 28672
    s_add_u32 s53, s53, s55
    v_lshlrev_b32 v5, 4, v5
    v_and_b32 v0, 31, v1
    v_mul_u32_u24 v0, 896, v0
    v_add3_u32 v5, v5, v0, s53
    s_waitcnt lgkmcnt(5)
    v_mfma_f32_16x16x32_bf16 v[72:75], a[224:227], v[224:227], v[72:75]
    ds_read_b128 v[16:19], v131 offset:36864
    v_mfma_f32_16x16x32_bf16 v[100:103], a[224:227], v[228:231], v[100:103]
    s_add_u32 s12, s59, 10240
    buffer_load_dwordx4 a[176:179], v7, s[32:35], s12 offen sc1
    v_mfma_f32_16x16x32_bf16 v[72:75], a[228:231], v[232:235], v[72:75]
    ds_read_b128 v[20:23], v131 offset:16384
    v_mfma_f32_16x16x32_bf16 v[100:103], a[228:231], v[236:239], v[100:103]
    s_waitcnt lgkmcnt(5)
    v_mfma_f32_16x16x32_bf16 v[72:75], a[232:235], v[240:243], v[72:75]
    ds_read_b128 v[24:27], v131 offset:23552
    v_mfma_f32_16x16x32_bf16 v[100:103], a[232:235], v[244:247], v[100:103]
    buffer_load_dwordx4 a[180:183], v8, s[32:35], s12 offen sc1
    v_mfma_f32_16x16x32_bf16 v[72:75], a[236:239], v[248:251], v[72:75]
    ds_read_b128 v[28:31], v131 offset:30720
    v_mfma_f32_16x16x32_bf16 v[100:103], a[236:239], v[252:255], v[100:103]
    s_waitcnt lgkmcnt(5)
    v_mfma_f32_16x16x32_bf16 v[76:79], a[240:243], v[224:227], v[76:79]
    ds_read_b128 v[32:35], v131 offset:37888
    v_mfma_f32_16x16x32_bf16 v[104:107], a[240:243], v[228:231], v[104:107]
    s_add_u32 s12, s26, 10240
    buffer_load_dwordx4 a[184:187], v7, s[32:35], s12 offen sc1
    v_mfma_f32_16x16x32_bf16 v[76:79], a[244:247], v[232:235], v[76:79]
    ds_read_b128 v[36:39], v131 offset:17408
    v_mfma_f32_16x16x32_bf16 v[104:107], a[244:247], v[236:239], v[104:107]
    s_waitcnt lgkmcnt(5)
    v_mfma_f32_16x16x32_bf16 v[76:79], a[248:251], v[240:243], v[76:79]
    ds_read_b128 v[40:43], v131 offset:24576
    v_mfma_f32_16x16x32_bf16 v[104:107], a[248:251], v[244:247], v[104:107]
    buffer_load_dwordx4 a[188:191], v8, s[32:35], s12 offen sc1
    v_mfma_f32_16x16x32_bf16 v[76:79], v[16:19], v[248:251], v[76:79]
    ds_read_b128 a[224:227], v131 offset:31744
    v_mfma_f32_16x16x32_bf16 v[104:107], v[16:19], v[252:255], v[104:107]
    v_pk_mul_f32 v[132:133], v[72:73], v[72:73]
    v_pk_mul_f32 v[134:135], v[74:75], v[74:75]
    v_pk_mul_f32 v[136:137], v[100:101], v[100:101]
    v_pk_mul_f32 v[138:139], v[102:103], v[102:103]
    v_pk_fma_f32 v[132:133], v[132:133], v[140:141], v[140:141] op_sel:[0,0,1] op_sel_hi:[1,0,1]
    v_pk_fma_f32 v[134:135], v[134:135], v[140:141], v[140:141] op_sel:[0,0,1] op_sel_hi:[1,0,1]
    v_pk_fma_f32 v[136:137], v[136:137], v[140:141], v[140:141] op_sel:[0,0,1] op_sel_hi:[1,0,1]
    v_pk_fma_f32 v[138:139], v[138:139], v[140:141], v[140:141] op_sel:[0,0,1] op_sel_hi:[1,0,1]
    v_pk_mul_f32 v[132:133], v[132:133], v[72:73]
    s_add_u32 s12, s11, 12288
    buffer_load_dwordx4 a[192:195], v7, s[32:35], s12 offen sc1
    v_pk_mul_f32 v[134:135], v[134:135], v[74:75]
    v_pk_mul_f32 v[136:137], v[136:137], v[100:101]
    v_pk_mul_f32 v[138:139], v[138:139], v[102:103]
    v_exp_f32 v132, v132
    v_exp_f32 v133, v133
    v_exp_f32 v134, v134
    buffer_load_dwordx4 a[196:199], v8, s[32:35], s12 offen sc1
    v_exp_f32 v135, v135
    v_exp_f32 v136, v136
    v_exp_f32 v137, v137
    v_exp_f32 v138, v138
    v_exp_f32 v139, v139
    s_add_u32 s12, s58, 12288
    buffer_load_dwordx4 a[200:203], v7, s[32:35], s12 offen sc1
    v_pk_add_f32 v[132:133], v[132:133], 1.0 op_sel_hi:[1,0]
    v_pk_add_f32 v[134:135], v[134:135], 1.0 op_sel_hi:[1,0]
    v_pk_add_f32 v[136:137], v[136:137], 1.0 op_sel_hi:[1,0]
    v_pk_add_f32 v[138:139], v[138:139], 1.0 op_sel_hi:[1,0]
    v_rcp_f32 v132, v132
    v_rcp_f32 v133, v133
    v_rcp_f32 v134, v134
    buffer_load_dwordx4 a[204:207], v8, s[32:35], s12 offen sc1
    v_rcp_f32 v135, v135
    v_rcp_f32 v136, v136
    v_rcp_f32 v137, v137
    v_rcp_f32 v138, v138
    v_rcp_f32 v139, v139
    s_add_u32 s12, s59, 12288
    buffer_load_dwordx4 a[208:211], v7, s[32:35], s12 offen sc1
    v_pk_mul_f32 v[132:133], v[132:133], v[72:73]
    v_pk_mul_f32 v[134:135], v[134:135], v[74:75]
    v_pk_mul_f32 v[136:137], v[136:137], v[100:101]
    v_pk_mul_f32 v[138:139], v[138:139], v[102:103]
    v_cvt_pk_bf16_f32 v44, v132, v133
    v_cvt_pk_bf16_f32 v45, v134, v135
    v_cvt_pk_bf16_f32 v46, v136, v137
    v_cvt_pk_bf16_f32 v47, v138, v139
    s_nop 0
    v_permlane32_swap_b32 v44, v46
    v_permlane32_swap_b32 v45, v47
    buffer_store_dwordx4 v[44:47], v128, s[32:35], s97 offen offset:0
    s_waitcnt lgkmcnt(5)
    v_mfma_f32_16x16x32_bf16 v[80:83], v[20:23], v[224:227], v[80:83]
    ds_read_b128 a[228:231], v131 offset:38912
    v_mfma_f32_16x16x32_bf16 v[108:111], v[20:23], v[228:231], v[108:111]
    buffer_load_dwordx4 a[212:215], v8, s[32:35], s12 offen sc1
    v_mfma_f32_16x16x32_bf16 v[80:83], v[24:27], v[232:235], v[80:83]
    ds_read_b128 a[232:235], v131 offset:18432
    v_mfma_f32_16x16x32_bf16 v[108:111], v[24:27], v[236:239], v[108:111]
    s_waitcnt lgkmcnt(5)
    v_mfma_f32_16x16x32_bf16 v[80:83], v[28:31], v[240:243], v[80:83]
    ds_read_b128 a[236:239], v131 offset:25600
    v_mfma_f32_16x16x32_bf16 v[108:111], v[28:31], v[244:247], v[108:111]
    s_add_u32 s12, s26, 12288
    buffer_load_dwordx4 a[216:219], v7, s[32:35], s12 offen sc1
    v_mfma_f32_16x16x32_bf16 v[80:83], v[32:35], v[248:251], v[80:83]
    ds_read_b128 a[240:243], v131 offset:32768
    v_mfma_f32_16x16x32_bf16 v[108:111], v[32:35], v[252:255], v[108:111]
    v_pk_mul_f32 v[132:133], v[76:77], v[76:77]
    v_pk_mul_f32 v[134:135], v[78:79], v[78:79]
    v_pk_mul_f32 v[136:137], v[104:105], v[104:105]
    v_pk_mul_f32 v[138:139], v[106:107], v[106:107]
    v_pk_fma_f32 v[132:133], v[132:133], v[140:141], v[140:141] op_sel:[0,0,1] op_sel_hi:[1,0,1]
    v_pk_fma_f32 v[134:135], v[134:135], v[140:141], v[140:141] op_sel:[0,0,1] op_sel_hi:[1,0,1]
    v_pk_fma_f32 v[136:137], v[136:137], v[140:141], v[140:141] op_sel:[0,0,1] op_sel_hi:[1,0,1]
    v_pk_fma_f32 v[138:139], v[138:139], v[140:141], v[140:141] op_sel:[0,0,1] op_sel_hi:[1,0,1]
    v_pk_mul_f32 v[132:133], v[132:133], v[76:77]
    buffer_load_dwordx4 a[220:223], v8, s[32:35], s12 offen sc1
    v_pk_mul_f32 v[134:135], v[134:135], v[78:79]
    v_pk_mul_f32 v[136:137], v[136:137], v[104:105]
    v_pk_mul_f32 v[138:139], v[138:139], v[106:107]
    v_exp_f32 v132, v132
    v_exp_f32 v133, v133
    v_exp_f32 v134, v134
    v_exp_f32 v135, v135
    v_exp_f32 v136, v136
    v_exp_f32 v137, v137
    v_exp_f32 v138, v138
    v_exp_f32 v139, v139
    v_pk_add_f32 v[132:133], v[132:133], 1.0 op_sel_hi:[1,0]
    v_pk_add_f32 v[134:135], v[134:135], 1.0 op_sel_hi:[1,0]
    v_pk_add_f32 v[136:137], v[136:137], 1.0 op_sel_hi:[1,0]
    v_pk_add_f32 v[138:139], v[138:139], 1.0 op_sel_hi:[1,0]
    v_rcp_f32 v132, v132
    v_rcp_f32 v133, v133
    v_rcp_f32 v134, v134
    v_rcp_f32 v135, v135
    v_rcp_f32 v136, v136
    v_rcp_f32 v137, v137
    v_rcp_f32 v138, v138
    v_rcp_f32 v139, v139
    v_pk_mul_f32 v[132:133], v[132:133], v[76:77]
    v_pk_mul_f32 v[134:135], v[134:135], v[78:79]
    v_pk_mul_f32 v[136:137], v[136:137], v[104:105]
    v_pk_mul_f32 v[138:139], v[138:139], v[106:107]
    v_cvt_pk_bf16_f32 v48, v132, v133
    v_cvt_pk_bf16_f32 v49, v134, v135
    v_cvt_pk_bf16_f32 v50, v136, v137
    v_cvt_pk_bf16_f32 v51, v138, v139
    s_nop 0
    v_permlane32_swap_b32 v48, v50
    v_permlane32_swap_b32 v49, v51
    buffer_store_dwordx4 v[48:51], v128, s[32:35], s97 offen offset:1024
    s_waitcnt lgkmcnt(5)
    v_mfma_f32_16x16x32_bf16 v[84:87], v[36:39], v[224:227], v[84:87]
    ds_read_b128 a[244:247], v131 offset:39936
    v_mfma_f32_16x16x32_bf16 v[112:115], v[36:39], v[228:231], v[112:115]
    v_mfma_f32_16x16x32_bf16 v[84:87], v[40:43], v[232:235], v[84:87]
    ds_read_b128 a[248:251], v131 offset:19456
    v_mfma_f32_16x16x32_bf16 v[112:115], v[40:43], v[236:239], v[112:115]
    s_waitcnt lgkmcnt(5)
    v_mfma_f32_16x16x32_bf16 v[84:87], a[224:227], v[240:243], v[84:87]
    ds_read_b128 v[16:19], v131 offset:26624
    v_mfma_f32_16x16x32_bf16 v[112:115], a[224:227], v[244:247], v[112:115]
    v_mfma_f32_16x16x32_bf16 v[84:87], a[228:231], v[248:251], v[84:87]
    ds_read_b128 v[20:23], v131 offset:33792
    v_mfma_f32_16x16x32_bf16 v[112:115], a[228:231], v[252:255], v[112:115]
    v_pk_mul_f32 v[132:133], v[80:81], v[80:81]
    v_pk_mul_f32 v[134:135], v[82:83], v[82:83]
    v_pk_mul_f32 v[136:137], v[108:109], v[108:109]
    v_pk_mul_f32 v[138:139], v[110:111], v[110:111]
    v_pk_fma_f32 v[132:133], v[132:133], v[140:141], v[140:141] op_sel:[0,0,1] op_sel_hi:[1,0,1]
    v_pk_fma_f32 v[134:135], v[134:135], v[140:141], v[140:141] op_sel:[0,0,1] op_sel_hi:[1,0,1]
    v_pk_fma_f32 v[136:137], v[136:137], v[140:141], v[140:141] op_sel:[0,0,1] op_sel_hi:[1,0,1]
    v_pk_fma_f32 v[138:139], v[138:139], v[140:141], v[140:141] op_sel:[0,0,1] op_sel_hi:[1,0,1]
    v_pk_mul_f32 v[132:133], v[132:133], v[80:81]
    v_pk_mul_f32 v[134:135], v[134:135], v[82:83]
    v_pk_mul_f32 v[136:137], v[136:137], v[108:109]
    v_pk_mul_f32 v[138:139], v[138:139], v[110:111]
    v_exp_f32 v132, v132
    v_exp_f32 v133, v133
    v_exp_f32 v134, v134
    v_exp_f32 v135, v135
    v_exp_f32 v136, v136
    v_exp_f32 v137, v137
    v_exp_f32 v138, v138
    v_exp_f32 v139, v139
    v_pk_add_f32 v[132:133], v[132:133], 1.0 op_sel_hi:[1,0]
    v_pk_add_f32 v[134:135], v[134:135], 1.0 op_sel_hi:[1,0]
    v_pk_add_f32 v[136:137], v[136:137], 1.0 op_sel_hi:[1,0]
    v_pk_add_f32 v[138:139], v[138:139], 1.0 op_sel_hi:[1,0]
    v_rcp_f32 v132, v132
    v_rcp_f32 v133, v133
    v_rcp_f32 v134, v134
    v_rcp_f32 v135, v135
    v_rcp_f32 v136, v136
    v_rcp_f32 v137, v137
    v_rcp_f32 v138, v138
    v_rcp_f32 v139, v139
    v_pk_mul_f32 v[132:133], v[132:133], v[80:81]
    v_pk_mul_f32 v[134:135], v[134:135], v[82:83]
    v_pk_mul_f32 v[136:137], v[136:137], v[108:109]
    v_pk_mul_f32 v[138:139], v[138:139], v[110:111]
    v_cvt_pk_bf16_f32 v52, v132, v133
    v_cvt_pk_bf16_f32 v53, v134, v135
    v_cvt_pk_bf16_f32 v54, v136, v137
    v_cvt_pk_bf16_f32 v55, v138, v139
    s_nop 0
    v_permlane32_swap_b32 v52, v54
    v_permlane32_swap_b32 v53, v55
    buffer_store_dwordx4 v[52:55], v128, s[32:35], s97 offen offset:2048
    s_waitcnt lgkmcnt(5)
    v_mfma_f32_16x16x32_bf16 v[88:91], a[232:235], v[224:227], v[88:91]
    ds_read_b128 v[24:27], v131 offset:40960
    v_mfma_f32_16x16x32_bf16 v[116:119], a[232:235], v[228:231], v[116:119]
    v_mfma_f32_16x16x32_bf16 v[88:91], a[236:239], v[232:235], v[88:91]
    ds_read_b128 v[28:31], v131 offset:20480
    v_mfma_f32_16x16x32_bf16 v[116:119], a[236:239], v[236:239], v[116:119]
    s_waitcnt lgkmcnt(5)
    v_mfma_f32_16x16x32_bf16 v[88:91], a[240:243], v[240:243], v[88:91]
    ds_read_b128 v[32:35], v131 offset:27648
    v_mfma_f32_16x16x32_bf16 v[116:119], a[240:243], v[244:247], v[116:119]
    v_mfma_f32_16x16x32_bf16 v[88:91], a[244:247], v[248:251], v[88:91]
    ds_read_b128 v[36:39], v131 offset:34816
    v_mfma_f32_16x16x32_bf16 v[116:119], a[244:247], v[252:255], v[116:119]
    v_pk_mul_f32 v[132:133], v[84:85], v[84:85]
    v_pk_mul_f32 v[134:135], v[86:87], v[86:87]
    v_pk_mul_f32 v[136:137], v[112:113], v[112:113]
    v_pk_mul_f32 v[138:139], v[114:115], v[114:115]
    v_pk_fma_f32 v[132:133], v[132:133], v[140:141], v[140:141] op_sel:[0,0,1] op_sel_hi:[1,0,1]
    v_pk_fma_f32 v[134:135], v[134:135], v[140:141], v[140:141] op_sel:[0,0,1] op_sel_hi:[1,0,1]
    v_pk_fma_f32 v[136:137], v[136:137], v[140:141], v[140:141] op_sel:[0,0,1] op_sel_hi:[1,0,1]
    v_pk_fma_f32 v[138:139], v[138:139], v[140:141], v[140:141] op_sel:[0,0,1] op_sel_hi:[1,0,1]
    v_pk_mul_f32 v[132:133], v[132:133], v[84:85]
    buffer_load_dwordx4 v[144:147], v142, s[32:35], s66 offen offset:0 sc1
    v_pk_mul_f32 v[134:135], v[134:135], v[86:87]
    v_pk_mul_f32 v[136:137], v[136:137], v[112:113]
    v_pk_mul_f32 v[138:139], v[138:139], v[114:115]
    v_exp_f32 v132, v132
    v_exp_f32 v133, v133
    v_exp_f32 v134, v134
    buffer_load_dwordx4 v[148:151], v143, s[32:35], s66 offen offset:0 sc1
    v_exp_f32 v135, v135
    v_exp_f32 v136, v136
    v_exp_f32 v137, v137
    v_exp_f32 v138, v138
    v_exp_f32 v139, v139
    buffer_load_dwordx4 v[152:155], v142, s[32:35], s67 offen offset:0 sc1
    v_pk_add_f32 v[132:133], v[132:133], 1.0 op_sel_hi:[1,0]
    v_pk_add_f32 v[134:135], v[134:135], 1.0 op_sel_hi:[1,0]
    v_pk_add_f32 v[136:137], v[136:137], 1.0 op_sel_hi:[1,0]
    v_pk_add_f32 v[138:139], v[138:139], 1.0 op_sel_hi:[1,0]
    v_rcp_f32 v132, v132
    v_rcp_f32 v133, v133
    v_rcp_f32 v134, v134
    buffer_load_dwordx4 v[156:159], v143, s[32:35], s67 offen offset:0 sc1
    v_rcp_f32 v135, v135
    v_rcp_f32 v136, v136
    v_rcp_f32 v137, v137
    v_rcp_f32 v138, v138
    v_rcp_f32 v139, v139
    buffer_load_dwordx4 v[160:163], v142, s[32:35], s68 offen offset:0 sc1
    v_pk_mul_f32 v[132:133], v[132:133], v[84:85]
    v_pk_mul_f32 v[134:135], v[134:135], v[86:87]
    v_pk_mul_f32 v[136:137], v[136:137], v[112:113]
    v_pk_mul_f32 v[138:139], v[138:139], v[114:115]
    v_cvt_pk_bf16_f32 v56, v132, v133
    v_cvt_pk_bf16_f32 v57, v134, v135
    v_cvt_pk_bf16_f32 v58, v136, v137
    v_cvt_pk_bf16_f32 v59, v138, v139
    s_nop 0
    v_permlane32_swap_b32 v56, v58
    v_permlane32_swap_b32 v57, v59
    buffer_store_dwordx4 v[56:59], v128, s[32:35], s97 offen offset:3072
    s_waitcnt lgkmcnt(5)
    v_mfma_f32_16x16x32_bf16 v[92:95], a[248:251], v[224:227], v[92:95]
    ds_read_b128 v[40:43], v131 offset:41984
    v_mfma_f32_16x16x32_bf16 v[120:123], a[248:251], v[228:231], v[120:123]
    buffer_load_dwordx4 v[164:167], v143, s[32:35], s68 offen offset:0 sc1
    v_mfma_f32_16x16x32_bf16 v[92:95], v[16:19], v[232:235], v[92:95]
    v_mfma_f32_16x16x32_bf16 v[120:123], v[16:19], v[236:239], v[120:123]
    s_waitcnt lgkmcnt(4)
    v_mfma_f32_16x16x32_bf16 v[92:95], v[20:23], v[240:243], v[92:95]
    v_mfma_f32_16x16x32_bf16 v[120:123], v[20:23], v[244:247], v[120:123]
    buffer_load_dwordx4 v[168:171], v142, s[32:35], s69 offen offset:0 sc1
    v_mfma_f32_16x16x32_bf16 v[92:95], v[24:27], v[248:251], v[92:95]
    v_mfma_f32_16x16x32_bf16 v[120:123], v[24:27], v[252:255], v[120:123]
    v_pk_mul_f32 v[132:133], v[88:89], v[88:89]
    v_pk_mul_f32 v[134:135], v[90:91], v[90:91]
    v_pk_mul_f32 v[136:137], v[116:117], v[116:117]
    v_pk_mul_f32 v[138:139], v[118:119], v[118:119]
    v_pk_fma_f32 v[132:133], v[132:133], v[140:141], v[140:141] op_sel:[0,0,1] op_sel_hi:[1,0,1]
    v_pk_fma_f32 v[134:135], v[134:135], v[140:141], v[140:141] op_sel:[0,0,1] op_sel_hi:[1,0,1]
    v_pk_fma_f32 v[136:137], v[136:137], v[140:141], v[140:141] op_sel:[0,0,1] op_sel_hi:[1,0,1]
    v_pk_fma_f32 v[138:139], v[138:139], v[140:141], v[140:141] op_sel:[0,0,1] op_sel_hi:[1,0,1]
    v_pk_mul_f32 v[132:133], v[132:133], v[88:89]
    buffer_load_dwordx4 v[172:175], v143, s[32:35], s69 offen offset:0 sc1
    v_pk_mul_f32 v[134:135], v[134:135], v[90:91]
    v_pk_mul_f32 v[136:137], v[136:137], v[116:117]
    v_pk_mul_f32 v[138:139], v[138:139], v[118:119]
    v_exp_f32 v132, v132
    v_exp_f32 v133, v133
    v_exp_f32 v134, v134
    buffer_load_dwordx4 v[176:179], v142, s[32:35], s66 offen offset:1024 sc1
    v_exp_f32 v135, v135
    v_exp_f32 v136, v136
    v_exp_f32 v137, v137
    v_exp_f32 v138, v138
    v_exp_f32 v139, v139
    buffer_load_dwordx4 v[180:183], v143, s[32:35], s66 offen offset:1024 sc1
    v_pk_add_f32 v[132:133], v[132:133], 1.0 op_sel_hi:[1,0]
    v_pk_add_f32 v[134:135], v[134:135], 1.0 op_sel_hi:[1,0]
    v_pk_add_f32 v[136:137], v[136:137], 1.0 op_sel_hi:[1,0]
    v_pk_add_f32 v[138:139], v[138:139], 1.0 op_sel_hi:[1,0]
    v_rcp_f32 v132, v132
    v_rcp_f32 v133, v133
    v_rcp_f32 v134, v134
    buffer_load_dwordx4 v[184:187], v142, s[32:35], s67 offen offset:1024 sc1
    v_rcp_f32 v135, v135
    v_rcp_f32 v136, v136
    v_rcp_f32 v137, v137
    v_rcp_f32 v138, v138
    v_rcp_f32 v139, v139
    buffer_load_dwordx4 v[188:191], v143, s[32:35], s67 offen offset:1024 sc1
    v_pk_mul_f32 v[132:133], v[132:133], v[88:89]
    v_pk_mul_f32 v[134:135], v[134:135], v[90:91]
    v_pk_mul_f32 v[136:137], v[136:137], v[116:117]
    v_pk_mul_f32 v[138:139], v[138:139], v[118:119]
    v_cvt_pk_bf16_f32 v60, v132, v133
    v_cvt_pk_bf16_f32 v61, v134, v135
    v_cvt_pk_bf16_f32 v62, v136, v137
    v_cvt_pk_bf16_f32 v63, v138, v139
    s_nop 0
    v_permlane32_swap_b32 v60, v62
    v_permlane32_swap_b32 v61, v63
    buffer_store_dwordx4 v[60:63], v129, s[32:35], s97 offen offset:0
    s_waitcnt lgkmcnt(2)
    v_mfma_f32_16x16x32_bf16 v[96:99], v[28:31], v[224:227], v[96:99]
    v_mfma_f32_16x16x32_bf16 v[124:127], v[28:31], v[228:231], v[124:127]
    buffer_load_dwordx4 v[192:195], v142, s[32:35], s68 offen offset:1024 sc1
    v_mfma_f32_16x16x32_bf16 v[96:99], v[32:35], v[232:235], v[96:99]
    v_mfma_f32_16x16x32_bf16 v[124:127], v[32:35], v[236:239], v[124:127]
    s_waitcnt lgkmcnt(0)
    v_mfma_f32_16x16x32_bf16 v[96:99], v[36:39], v[240:243], v[96:99]
    v_mfma_f32_16x16x32_bf16 v[124:127], v[36:39], v[244:247], v[124:127]
    buffer_load_dwordx4 v[196:199], v143, s[32:35], s68 offen offset:1024 sc1
    v_mfma_f32_16x16x32_bf16 v[96:99], v[40:43], v[248:251], v[96:99]
    v_mfma_f32_16x16x32_bf16 v[124:127], v[40:43], v[252:255], v[124:127]
    s_cmp_eq_u32 s100, 0
    s_cbranch_scc1 L_slow13
L_back13:
    s_waitcnt vmcnt(7)
    v_max3_u32 v9, v144, v148, v152
    v_max3_u32 v9, v9, v156, v160
    v_max3_u32 v9, v9, v164, v168
    v_max3_u32 v9, v9, v172, v172
    v_cmp_eq_u32 vcc, -1, v9
    s_nop 1
    s_cbranch_vccnz L_slow14
L_back14:
    v_pk_mul_f32 v[132:133], v[92:93], v[92:93]
    v_pk_mul_f32 v[134:135], v[94:95], v[94:95]
    v_pk_mul_f32 v[136:137], v[120:121], v[120:121]
    v_pk_mul_f32 v[138:139], v[122:123], v[122:123]
    v_pk_fma_f32 v[132:133], v[132:133], v[140:141], v[140:141] op_sel:[0,0,1] op_sel_hi:[1,0,1]
    v_pk_fma_f32 v[134:135], v[134:135], v[140:141], v[140:141] op_sel:[0,0,1] op_sel_hi:[1,0,1]
    v_pk_fma_f32 v[136:137], v[136:137], v[140:141], v[140:141] op_sel:[0,0,1] op_sel_hi:[1,0,1]
    v_pk_fma_f32 v[138:139], v[138:139], v[140:141], v[140:141] op_sel:[0,0,1] op_sel_hi:[1,0,1]
    v_pk_mul_f32 v[132:133], v[132:133], v[92:93]
    v_mfma_f32_32x32x16_bf16 a[240:255], a[4:7], v[148:151], 0
    buffer_load_dwordx4 v[200:203], v142, s[32:35], s69 offen offset:1024 sc1
    v_pk_mul_f32 v[134:135], v[134:135], v[94:95]
    v_pk_mul_f32 v[136:137], v[136:137], v[120:121]
    v_pk_mul_f32 v[138:139], v[138:139], v[122:123]
    v_exp_f32 v132, v132
    v_exp_f32 v133, v133
    v_exp_f32 v134, v134
    v_mfma_f32_32x32x16_bf16 a[224:239], a[4:7], v[144:147], 0
    buffer_load_dwordx4 v[204:207], v143, s[32:35], s69 offen offset:1024 sc1
    v_exp_f32 v135, v135
    v_exp_f32 v136, v136
    v_exp_f32 v137, v137
    v_exp_f32 v138, v138
    v_exp_f32 v139, v139
    v_mfma_f32_32x32x16_bf16 v[100:115], a[0:3], v[148:151], 0
    buffer_load_dwordx4 v[208:211], v142, s[32:35], s66 offen offset:2048 sc1
    v_pk_add_f32 v[132:133], v[132:133], 1.0 op_sel_hi:[1,0]
    v_pk_add_f32 v[134:135], v[134:135], 1.0 op_sel_hi:[1,0]
    v_pk_add_f32 v[136:137], v[136:137], 1.0 op_sel_hi:[1,0]
    v_pk_add_f32 v[138:139], v[138:139], 1.0 op_sel_hi:[1,0]
    v_rcp_f32 v132, v132
    v_rcp_f32 v133, v133
    v_rcp_f32 v134, v134
    v_mfma_f32_32x32x16_bf16 v[72:87], a[0:3], v[144:147], 0
    buffer_load_dwordx4 v[212:215], v143, s[32:35], s66 offen offset:2048 sc1
    v_rcp_f32 v135, v135
    v_rcp_f32 v136, v136
    v_rcp_f32 v137, v137
    v_rcp_f32 v138, v138
    v_rcp_f32 v139, v139
    v_mfma_f32_32x32x16_bf16 a[240:255], a[12:15], v[156:159], a[240:255]
    buffer_load_dwordx4 v[216:219], v142, s[32:35], s67 offen offset:2048 sc1
    v_pk_mul_f32 v[132:133], v[132:133], v[92:93]
    v_pk_mul_f32 v[134:135], v[134:135], v[94:95]
    v_pk_mul_f32 v[136:137], v[136:137], v[120:121]
    v_pk_mul_f32 v[138:139], v[138:139], v[122:123]
    v_cvt_pk_bf16_f32 v64, v132, v133
    v_cvt_pk_bf16_f32 v65, v134, v135
    v_cvt_pk_bf16_f32 v66, v136, v137
    v_cvt_pk_bf16_f32 v67, v138, v139
    s_nop 0
    v_permlane32_swap_b32 v64, v66
    v_permlane32_swap_b32 v65, v67
    buffer_store_dwordx4 v[64:67], v129, s[32:35], s97 offen offset:1024
    v_pk_mul_f32 v[132:133], v[96:97], v[96:97]
    v_pk_mul_f32 v[134:135], v[98:99], v[98:99]
    v_pk_mul_f32 v[136:137], v[124:125], v[124:125]
    v_pk_mul_f32 v[138:139], v[126:127], v[126:127]
    v_pk_fma_f32 v[132:133], v[132:133], v[140:141], v[140:141] op_sel:[0,0,1] op_sel_hi:[1,0,1]
    v_pk_fma_f32 v[134:135], v[134:135], v[140:141], v[140:141] op_sel:[0,0,1] op_sel_hi:[1,0,1]
    v_pk_fma_f32 v[136:137], v[136:137], v[140:141], v[140:141] op_sel:[0,0,1] op_sel_hi:[1,0,1]
    v_pk_fma_f32 v[138:139], v[138:139], v[140:141], v[140:141] op_sel:[0,0,1] op_sel_hi:[1,0,1]
    v_pk_mul_f32 v[132:133], v[132:133], v[96:97]
    v_mfma_f32_32x32x16_bf16 a[224:239], a[12:15], v[152:155], a[224:239]
    buffer_load_dwordx4 v[220:223], v143, s[32:35], s67 offen offset:2048 sc1
    v_pk_mul_f32 v[134:135], v[134:135], v[98:99]
    v_pk_mul_f32 v[136:137], v[136:137], v[124:125]
    v_pk_mul_f32 v[138:139], v[138:139], v[126:127]
    v_exp_f32 v132, v132
    v_exp_f32 v133, v133
    v_exp_f32 v134, v134
    v_mfma_f32_32x32x16_bf16 v[100:115], a[8:11], v[156:159], v[100:115]
    buffer_load_dwordx4 v[224:227], v142, s[32:35], s68 offen offset:2048 sc1
    v_exp_f32 v135, v135
    v_exp_f32 v136, v136
    v_exp_f32 v137, v137
    v_exp_f32 v138, v138
    v_exp_f32 v139, v139
    v_mfma_f32_32x32x16_bf16 v[72:87], a[8:11], v[152:155], v[72:87]
    buffer_load_dwordx4 v[228:231], v143, s[32:35], s68 offen offset:2048 sc1
    v_pk_add_f32 v[132:133], v[132:133], 1.0 op_sel_hi:[1,0]
    v_pk_add_f32 v[134:135], v[134:135], 1.0 op_sel_hi:[1,0]
    v_pk_add_f32 v[136:137], v[136:137], 1.0 op_sel_hi:[1,0]
    v_pk_add_f32 v[138:139], v[138:139], 1.0 op_sel_hi:[1,0]
    v_rcp_f32 v132, v132
    v_rcp_f32 v133, v133
    v_rcp_f32 v134, v134
    v_mfma_f32_32x32x16_bf16 a[240:255], a[20:23], v[164:167], a[240:255]
    buffer_load_dwordx4 v[232:235], v142, s[32:35], s69 offen offset:2048 sc1
    v_rcp_f32 v135, v135
    v_rcp_f32 v136, v136
    v_rcp_f32 v137, v137
    v_rcp_f32 v138, v138
    v_rcp_f32 v139, v139
    v_mfma_f32_32x32x16_bf16 a[224:239], a[20:23], v[160:163], a[224:239]
    buffer_load_dwordx4 v[236:239], v143, s[32:35], s69 offen offset:2048 sc1
    v_pk_mul_f32 v[132:133], v[132:133], v[96:97]
    v_pk_mul_f32 v[134:135], v[134:135], v[98:99]
    v_pk_mul_f32 v[136:137], v[136:137], v[124:125]
    v_pk_mul_f32 v[138:139], v[138:139], v[126:127]
    v_cvt_pk_bf16_f32 v68, v132, v133
    v_cvt_pk_bf16_f32 v69, v134, v135
    v_cvt_pk_bf16_f32 v70, v136, v137
    v_cvt_pk_bf16_f32 v71, v138, v139
    s_nop 0
    v_permlane32_swap_b32 v68, v70
    v_permlane32_swap_b32 v69, v71
    buffer_store_dwordx4 v[68:71], v129, s[32:35], s97 offen offset:2048
    s_cmp_eq_u32 s100, 0
    s_cbranch_scc1 L_slow15
L_back15:
    s_cmp_ge_u32 s49, 28
    s_cbranch_scc1 L_end
    v_mfma_f32_32x32x16_bf16 v[100:115], a[16:19], v[164:167], v[100:115]
    buffer_load_dwordx4 v[240:243], v142, s[32:35], s66 offen offset:3072 sc1
    v_mfma_f32_32x32x16_bf16 v[72:87], a[16:19], v[160:163], v[72:87]
    buffer_load_dwordx4 v[120:123], v15, s[32:35], s73 offen offset:0 sc1
    v_mfma_f32_32x32x16_bf16 a[240:255], a[28:31], v[172:175], a[240:255]
    buffer_load_dwordx4 v[244:247], v143, s[32:35], s66 offen offset:3072 sc1
    v_mfma_f32_32x32x16_bf16 a[224:239], a[28:31], v[168:171], a[224:239]
    buffer_load_dwordx4 v[124:127], v15, s[32:35], s73 offen offset:512 sc1
    v_mfma_f32_32x32x16_bf16 v[100:115], a[24:27], v[172:175], v[100:115]
    buffer_load_dwordx4 v[248:251], v142, s[32:35], s67 offen offset:3072 sc1
    s_waitcnt vmcnt(15)
    v_max3_u32 v9, v176, v180, v184
    v_max3_u32 v9, v9, v188, v192
    v_max3_u32 v9, v9, v196, v200
    v_max3_u32 v9, v9, v204, v204
    v_cmp_eq_u32 vcc, -1, v9
    s_nop 1
    s_cbranch_vccnz L_slow16
L_back16:
    v_mfma_f32_32x32x16_bf16 v[72:87], a[24:27], v[168:171], v[72:87]
    buffer_load_dwordx2 v[138:139], v2, s[32:35], s62 offen sc1
    v_mfma_f32_32x32x16_bf16 a[240:255], a[36:39], v[180:183], a[240:255]
    buffer_load_dwordx4 v[252:255], v143, s[32:35], s67 offen offset:3072 sc1
    v_mfma_f32_32x32x16_bf16 a[224:239], a[36:39], v[176:179], a[224:239]
    s_xor_b32 s52, s30, 1
    s_mul_i32 s52, s52, 12288
    s_add_u32 s52, s52, 0
    v_mfma_f32_32x32x16_bf16 v[100:115], a[32:35], v[180:183], v[100:115]
    buffer_load_dwordx4 v[16:19], v142, s[32:35], s68 offen offset:3072 sc1
    v_mfma_f32_32x32x16_bf16 v[72:87], a[32:35], v[176:179], v[72:87]
    v_add_u32 v128, s52, v4
    s_xor_b32 s52, s30, 2
    s_mul_i32 s52, s52, 12288
    v_mfma_f32_32x32x16_bf16 a[240:255], a[44:47], v[188:191], a[240:255]
    buffer_load_dwordx4 v[20:23], v143, s[32:35], s68 offen offset:3072 sc1
    v_mfma_f32_32x32x16_bf16 a[224:239], a[44:47], v[184:187], a[224:239]
    s_add_u32 s52, s52, 4096
    v_add_u32 v129, s52, v4
    s_xor_b32 s52, s30, 3
    v_mfma_f32_32x32x16_bf16 v[100:115], a[40:43], v[188:191], v[100:115]
    buffer_load_dwordx4 v[24:27], v142, s[32:35], s69 offen offset:3072 sc1
    v_mfma_f32_32x32x16_bf16 v[72:87], a[40:43], v[184:187], v[72:87]
    s_mul_i32 s52, s52, 12288
    s_add_u32 s52, s52, 8192
    v_add_u32 v130, s52, v4
    v_mfma_f32_32x32x16_bf16 a[240:255], a[52:55], v[196:199], a[240:255]
    buffer_load_dwordx4 v[28:31], v143, s[32:35], s69 offen offset:3072 sc1
    v_mfma_f32_32x32x16_bf16 a[224:239], a[52:55], v[192:195], a[224:239]
    s_mul_i32 s52, s30, 12288
    s_add_u32 s52, s52, 0
    v_add_u32 v131, s52, v4
    v_mfma_f32_32x32x16_bf16 v[100:115], a[48:51], v[196:199], v[100:115]
    buffer_load_dwordx4 v[32:35], v6, s[32:35], s66 offen offset:0 sc1
    v_mfma_f32_32x32x16_bf16 v[72:87], a[48:51], v[192:195], v[72:87]
    v_mov_b32 v134, 0xffff0000
    v_mov_b32 v135, 0x10000
    s_mov_b32 s36, s24
    v_mfma_f32_32x32x16_bf16 a[240:255], a[60:63], v[204:207], a[240:255]
    buffer_load_dwordx4 v[36:39], v10, s[32:35], s66 offen offset:0 sc1
    v_mfma_f32_32x32x16_bf16 a[224:239], a[60:63], v[200:203], a[224:239]
    s_mov_b32 s37, s25
    s_mov_b32 s38, 1835008
    v_mfma_f32_32x32x16_bf16 v[100:115], a[56:59], v[204:207], v[100:115]
    s_waitcnt vmcnt(14)
    v_max3_u32 v9, v208, v212, v216
    v_max3_u32 v9, v9, v220, v224
    v_max3_u32 v9, v9, v228, v232
    v_max3_u32 v9, v9, v236, v236
    v_cmp_eq_u32 vcc, -1, v9
    s_nop 1
    s_cbranch_vccnz L_slow17
L_back17:
    v_mfma_f32_32x32x16_bf16 v[72:87], a[56:59], v[200:203], v[72:87]
    v_mfma_f32_32x32x16_bf16 a[240:255], a[68:71], v[212:215], a[240:255]
    buffer_load_dwordx4 v[40:43], v6, s[32:35], s67 offen offset:0 sc1
    v_mfma_f32_32x32x16_bf16 a[224:239], a[68:71], v[208:211], a[224:239]
    s_waitcnt vmcnt(8)
    v_max3_u32 v9, v120, v124, v139
    v_cmp_eq_u32 vcc, -1, v9
    s_nop 1
    s_cbranch_vccnz L_slow18
L_back18:
    v_mfma_f32_32x32x16_bf16 v[100:115], a[64:67], v[212:215], v[100:115]
    buffer_load_dwordx4 v[44:47], v10, s[32:35], s67 offen offset:0 sc1
    v_mfma_f32_32x32x16_bf16 v[72:87], a[64:67], v[208:211], v[72:87]
    v_permlane32_swap_b32 v120, v122
    v_permlane32_swap_b32 v121, v123
    v_mfma_f32_32x32x16_bf16 a[240:255], a[76:79], v[220:223], a[240:255]
    buffer_load_dwordx4 v[48:51], v6, s[32:35], s68 offen offset:0 sc1
    v_mfma_f32_32x32x16_bf16 a[224:239], a[76:79], v[216:219], a[224:239]
    v_permlane32_swap_b32 v124, v126
    v_permlane32_swap_b32 v125, v127
    v_mfma_f32_32x32x16_bf16 v[100:115], a[72:75], v[220:223], v[100:115]
    buffer_load_dwordx4 v[52:55], v10, s[32:35], s68 offen offset:0 sc1
    v_mfma_f32_32x32x16_bf16 v[72:87], a[72:75], v[216:219], v[72:87]
    v_mul_u32_u24_dpp v88, v11, v135 row_newbcast:0 row_mask:0xf bank_mask:0xf
    v_and_b32_dpp v89, v11, v134 row_newbcast:0 row_mask:0xf bank_mask:0xf
    v_lshlrev_b32 v136, 16, v120
    v_and_b32 v137, 0xffff0000, v120
    v_fma_f32 v136, v136, v139, v138
    v_fma_f32 v137, v137, v139, v138
    v_add_f32 v88, v88, v136
    v_add_f32 v89, v89, v137
    v_mfma_f32_32x32x16_bf16 a[240:255], a[84:87], v[228:231], a[240:255]
    buffer_load_dwordx4 v[56:59], v6, s[32:35], s69 offen offset:0 sc1
    v_mfma_f32_32x32x16_bf16 a[224:239], a[84:87], v[224:227], a[224:239]
    v_mul_u32_u24_dpp v90, v12, v135 row_newbcast:0 row_mask:0xf bank_mask:0xf
    v_and_b32_dpp v91, v12, v134 row_newbcast:0 row_mask:0xf bank_mask:0xf
    v_lshlrev_b32 v136, 16, v121
    v_and_b32 v137, 0xffff0000, v121
    v_fma_f32 v136, v136, v139, v138
    v_fma_f32 v137, v137, v139, v138
    v_add_f32 v90, v90, v136
    v_add_f32 v91, v91, v137
    v_mfma_f32_32x32x16_bf16 v[100:115], a[80:83], v[228:231], v[100:115]
    buffer_load_dwordx4 v[60:63], v10, s[32:35], s69 offen offset:0 sc1
    v_mfma_f32_32x32x16_bf16 v[72:87], a[80:83], v[224:227], v[72:87]
    v_mul_u32_u24_dpp v92, v11, v135 row_newbcast:1 row_mask:0xf bank_mask:0xf
    v_and_b32_dpp v93, v11, v134 row_newbcast:1 row_mask:0xf bank_mask:0xf
    v_lshlrev_b32 v136, 16, v122
    v_and_b32 v137, 0xffff0000, v122
    v_fma_f32 v136, v136, v139, v138
    v_fma_f32 v137, v137, v139, v138
    v_add_f32 v92, v92, v136
    v_add_f32 v93, v93, v137
    v_mfma_f32_32x32x16_bf16 a[240:255], a[92:95], v[236:239], a[240:255]
    buffer_load_dwordx4 v[64:67], v6, s[32:35], s66 offen offset:1024 sc1
    v_mfma_f32_32x32x16_bf16 a[224:239], a[92:95], v[232:235], a[224:239]
    v_mul_u32_u24_dpp v94, v12, v135 row_newbcast:1 row_mask:0xf bank_mask:0xf
    v_and_b32_dpp v95, v12, v134 row_newbcast:1 row_mask:0xf bank_mask:0xf
    v_lshlrev_b32 v136, 16, v123
    v_and_b32 v137, 0xffff0000, v123
    v_fma_f32 v136, v136, v139, v138
    v_fma_f32 v137, v137, v139, v138
    v_add_f32 v94, v94, v136
    v_add_f32 v95, v95, v137
    v_mfma_f32_32x32x16_bf16 v[100:115], a[88:91], v[236:239], v[100:115]
    s_waitcnt vmcnt(9)
    v_max3_u32 v9, v240, v244, v248
    v_max3_u32 v9, v9, v252, v16
    v_max3_u32 v9, v9, v20, v24
    v_max3_u32 v9, v9, v28, v28
    v_cmp_eq_u32 vcc, -1, v9
    s_nop 1
    s_cbranch_vccnz L_slow19
L_back19:
    v_mfma_f32_32x32x16_bf16 v[72:87], a[88:91], v[232:235], v[72:87]
    v_mul_u32_u24_dpp v96, v11, v135 row_newbcast:2 row_mask:0xf bank_mask:0xf
    v_and_b32_dpp v97, v11, v134 row_newbcast:2 row_mask:0xf bank_mask:0xf
    v_lshlrev_b32 v136, 16, v124
    v_and_b32 v137, 0xffff0000, v124
    v_fma_f32 v136, v136, v139, v138
    v_fma_f32 v137, v137, v139, v138
    v_add_f32 v96, v96, v136
    v_add_f32 v97, v97, v137
    v_mfma_f32_32x32x16_bf16 a[240:255], a[100:103], v[244:247], a[240:255]
    buffer_load_dwordx4 v[68:71], v10, s[32:35], s66 offen offset:1024 sc1
    v_mfma_f32_32x32x16_bf16 a[224:239], a[100:103], v[240:243], a[224:239]
    v_mul_u32_u24_dpp v98, v12, v135 row_newbcast:2 row_mask:0xf bank_mask:0xf
    v_and_b32_dpp v99, v12, v134 row_newbcast:2 row_mask:0xf bank_mask:0xf
    v_lshlrev_b32 v136, 16, v125
    v_and_b32 v137, 0xffff0000, v125
    v_fma_f32 v136, v136, v139, v138
    v_fma_f32 v137, v137, v139, v138
    v_add_f32 v98, v98, v136
    v_add_f32 v99, v99, v137
    v_mfma_f32_32x32x16_bf16 v[100:115], a[96:99], v[244:247], v[100:115]
    buffer_load_dwordx4 v[144:147], v6, s[32:35], s67 offen offset:1024 sc1
    v_mfma_f32_32x32x16_bf16 v[72:87], a[96:99], v[240:243], v[72:87]
    v_mul_u32_u24_dpp v116, v11, v135 row_newbcast:3 row_mask:0xf bank_mask:0xf
    v_and_b32_dpp v117, v11, v134 row_newbcast:3 row_mask:0xf bank_mask:0xf
    v_lshlrev_b32 v136, 16, v126
    v_and_b32 v137, 0xffff0000, v126
    v_fma_f32 v136, v136, v139, v138
    v_fma_f32 v137, v137, v139, v138
    v_add_f32 v116, v116, v136
    v_add_f32 v117, v117, v137
    v_mfma_f32_32x32x16_bf16 a[240:255], a[108:111], v[252:255], a[240:255]
    buffer_load_dwordx4 v[148:151], v10, s[32:35], s67 offen offset:1024 sc1
    v_mfma_f32_32x32x16_bf16 a[224:239], a[108:111], v[248:251], a[224:239]
    v_mul_u32_u24_dpp v118, v12, v135 row_newbcast:3 row_mask:0xf bank_mask:0xf
    v_and_b32_dpp v119, v12, v134 row_newbcast:3 row_mask:0xf bank_mask:0xf
    v_lshlrev_b32 v136, 16, v127
    v_and_b32 v137, 0xffff0000, v127
    v_fma_f32 v136, v136, v139, v138
    v_fma_f32 v137, v137, v139, v138
    v_add_f32 v118, v118, v136
    v_add_f32 v119, v119, v137
    v_mfma_f32_32x32x16_bf16 v[100:115], a[104:107], v[252:255], v[100:115]
    buffer_load_dwordx4 v[152:155], v6, s[32:35], s68 offen offset:1024 sc1
    v_mfma_f32_32x32x16_bf16 v[72:87], a[104:107], v[248:251], v[72:87]
    v_mfma_f32_32x32x16_bf16 a[240:255], a[116:119], v[20:23], a[240:255]
    buffer_load_dwordx4 v[156:159], v10, s[32:35], s68 offen offset:1024 sc1
    v_mfma_f32_32x32x16_bf16 a[224:239], a[116:119], v[16:19], a[224:239]
    v_mfma_f32_32x32x16_bf16 v[100:115], a[112:115], v[20:23], v[100:115]
    buffer_load_dwordx4 v[160:163], v6, s[32:35], s69 offen offset:1024 sc1
    v_mfma_f32_32x32x16_bf16 v[72:87], a[112:115], v[16:19], v[72:87]
    v_mfma_f32_32x32x16_bf16 a[240:255], a[124:127], v[28:31], a[240:255]
    buffer_load_dwordx4 v[164:167], v10, s[32:35], s69 offen offset:1024 sc1
    v_mfma_f32_32x32x16_bf16 a[224:239], a[124:127], v[24:27], a[224:239]
    v_mfma_f32_32x32x16_bf16 v[100:115], a[120:123], v[28:31], v[100:115]
    s_waitcnt vmcnt(8)
    v_max3_u32 v9, v32, v36, v40
    v_max3_u32 v9, v9, v44, v48
    v_max3_u32 v9, v9, v52, v56
    v_max3_u32 v9, v9, v60, v60
    v_cmp_eq_u32 vcc, -1, v9
    s_nop 1
    s_cbranch_vccnz L_slow20
L_back20:
    v_mfma_f32_32x32x16_bf16 v[72:87], a[120:123], v[24:27], v[72:87]
    v_mfma_f32_32x32x16_bf16 a[240:255], a[132:135], v[36:39], a[240:255]
    buffer_load_dwordx4 v[168:171], v6, s[32:35], s66 offen offset:2048 sc1
    v_mfma_f32_32x32x16_bf16 a[224:239], a[132:135], v[32:35], a[224:239]
    v_mfma_f32_32x32x16_bf16 v[100:115], a[128:131], v[36:39], v[100:115]
    buffer_load_dwordx4 v[172:175], v10, s[32:35], s66 offen offset:2048 sc1
    v_mfma_f32_32x32x16_bf16 v[72:87], a[128:131], v[32:35], v[72:87]
    v_mfma_f32_32x32x16_bf16 a[240:255], a[140:143], v[44:47], a[240:255]
    buffer_load_dwordx4 v[176:179], v6, s[32:35], s67 offen offset:2048 sc1
    v_mfma_f32_32x32x16_bf16 a[224:239], a[140:143], v[40:43], a[224:239]
    v_mfma_f32_32x32x16_bf16 v[100:115], a[136:139], v[44:47], v[100:115]
    buffer_load_dwordx4 v[180:183], v10, s[32:35], s67 offen offset:2048 sc1
    v_mfma_f32_32x32x16_bf16 v[72:87], a[136:139], v[40:43], v[72:87]
    v_mfma_f32_32x32x16_bf16 a[240:255], a[148:151], v[52:55], a[240:255]
    buffer_load_dwordx4 v[184:187], v6, s[32:35], s68 offen offset:2048 sc1
    v_mfma_f32_32x32x16_bf16 a[224:239], a[148:151], v[48:51], a[224:239]
    v_mfma_f32_32x32x16_bf16 v[100:115], a[144:147], v[52:55], v[100:115]
    buffer_load_dwordx4 v[188:191], v10, s[32:35], s68 offen offset:2048 sc1
    v_mfma_f32_32x32x16_bf16 v[72:87], a[144:147], v[48:51], v[72:87]
    v_mfma_f32_32x32x16_bf16 a[240:255], a[156:159], v[60:63], a[240:255]
    buffer_load_dwordx4 v[192:195], v6, s[32:35], s69 offen offset:2048 sc1
    v_mfma_f32_32x32x16_bf16 a[224:239], a[156:159], v[56:59], a[224:239]
    v_mfma_f32_32x32x16_bf16 v[100:115], a[152:155], v[60:63], v[100:115]
    s_waitcnt vmcnt(7)
    v_max3_u32 v9, v64, v68, v144
    v_max3_u32 v9, v9, v148, v152
    v_max3_u32 v9, v9, v156, v160
    v_max3_u32 v9, v9, v164, v164
    v_cmp_eq_u32 vcc, -1, v9
    s_nop 1
    s_cbranch_vccnz L_slow21
L_back21:
    v_mfma_f32_32x32x16_bf16 v[72:87], a[152:155], v[56:59], v[72:87]
    v_mfma_f32_32x32x16_bf16 a[240:255], a[164:167], v[68:71], a[240:255]
    buffer_load_dwordx4 v[196:199], v10, s[32:35], s69 offen offset:2048 sc1
    v_mfma_f32_32x32x16_bf16 a[224:239], a[164:167], v[64:67], a[224:239]
    v_mfma_f32_32x32x16_bf16 v[100:115], a[160:163], v[68:71], v[100:115]
    v_mfma_f32_32x32x16_bf16 v[72:87], a[160:163], v[64:67], v[72:87]
    v_mfma_f32_32x32x16_bf16 a[240:255], a[172:175], v[148:151], a[240:255]
    v_mfma_f32_32x32x16_bf16 a[224:239], a[172:175], v[144:147], a[224:239]
    v_mfma_f32_32x32x16_bf16 v[100:115], a[168:171], v[148:151], v[100:115]
    v_mfma_f32_32x32x16_bf16 v[72:87], a[168:171], v[144:147], v[72:87]
    v_mfma_f32_32x32x16_bf16 a[240:255], a[180:183], v[156:159], a[240:255]
    v_mfma_f32_32x32x16_bf16 a[224:239], a[180:183], v[152:155], a[224:239]
    v_mfma_f32_32x32x16_bf16 v[100:115], a[176:179], v[156:159], v[100:115]
    v_mfma_f32_32x32x16_bf16 v[72:87], a[176:179], v[152:155], v[72:87]
    v_mfma_f32_32x32x16_bf16 a[240:255], a[188:191], v[164:167], a[240:255]
    v_mfma_f32_32x32x16_bf16 a[224:239], a[188:191], v[160:163], a[224:239]
    v_mfma_f32_32x32x16_bf16 v[100:115], a[184:187], v[164:167], v[100:115]
    s_waitcnt vmcnt(0)
    v_max3_u32 v9, v168, v172, v176
    v_max3_u32 v9, v9, v180, v184
    v_max3_u32 v9, v9, v188, v192
    v_max3_u32 v9, v9, v196, v196
    v_cmp_eq_u32 vcc, -1, v9
    s_nop 1
    s_cbranch_vccnz L_slow22
L_back22:
    v_mfma_f32_32x32x16_bf16 v[72:87], a[184:187], v[160:163], v[72:87]
    v_mfma_f32_32x32x16_bf16 a[240:255], a[196:199], v[172:175], a[240:255]
    v_mfma_f32_32x32x16_bf16 a[240:255], a[204:207], v[180:183], a[240:255]
    v_mfma_f32_32x32x16_bf16 a[240:255], a[212:215], v[188:191], a[240:255]
    v_mfma_f32_32x32x16_bf16 a[240:255], a[220:223], v[196:199], a[240:255]
    v_mfma_f32_32x32x16_bf16 a[224:239], a[196:199], v[168:171], a[224:239]
    v_mfma_f32_32x32x16_bf16 a[224:239], a[204:207], v[176:179], a[224:239]
    v_mfma_f32_32x32x16_bf16 a[224:239], a[212:215], v[184:187], a[224:239]
    s_nop 7
    s_nop 0
    ds_write_b128 v130, a[240:243] offset:0
    ds_write_b128 v130, a[244:247] offset:1024
    v_mfma_f32_32x32x16_bf16 a[224:239], a[220:223], v[192:195], a[224:239]
    ds_write_b128 v130, a[248:251] offset:2048
    ds_write_b128 v130, a[252:255] offset:3072
    v_mfma_f32_32x32x16_bf16 v[100:115], a[192:195], v[172:175], v[100:115]
    v_mfma_f32_32x32x16_bf16 v[100:115], a[200:203], v[180:183], v[100:115]
    v_mfma_f32_32x32x16_bf16 v[100:115], a[208:211], v[188:191], v[100:115]
    s_nop 6
    ds_write_b128 v129, a[224:227] offset:0
    ds_write_b128 v129, a[228:231] offset:1024
    v_mfma_f32_32x32x16_bf16 v[100:115], a[216:219], v[196:199], v[100:115]
    ds_write_b128 v129, a[232:235] offset:2048
    ds_write_b128 v129, a[236:239] offset:3072
    v_mfma_f32_32x32x16_bf16 v[72:87], a[192:195], v[168:171], v[72:87]
    v_mfma_f32_32x32x16_bf16 v[72:87], a[200:203], v[176:179], v[72:87]
    v_mfma_f32_32x32x16_bf16 v[72:87], a[208:211], v[184:187], v[72:87]
    s_nop 6
    ds_write_b128 v128, v[100:103] offset:0
    ds_write_b128 v128, v[104:107] offset:1024
    v_mfma_f32_32x32x16_bf16 v[72:87], a[216:219], v[192:195], v[72:87]
    ds_write_b128 v128, v[108:111] offset:2048
    ds_write_b128 v128, v[112:115] offset:3072
    s_waitcnt lgkmcnt(0)
    s_barrier
    ds_read_b128 v[144:147], v131 offset:0
    ds_read_b128 v[148:151], v131 offset:1024
    ds_read_b128 v[160:163], v131 offset:4096
    ds_read_b128 v[164:167], v131 offset:5120
    ds_read_b128 v[176:179], v131 offset:8192
    ds_read_b128 v[180:183], v131 offset:9216
    ds_read_b128 v[152:155], v131 offset:2048
    ds_read_b128 v[156:159], v131 offset:3072
    ds_read_b128 v[168:171], v131 offset:6144
    ds_read_b128 v[172:175], v131 offset:7168
    ds_read_b128 v[184:187], v131 offset:10240
    ds_read_b128 v[188:191], v131 offset:11264
    v_pk_add_f32 v[72:73], v[72:73], v[88:89]
    v_pk_add_f32 v[74:75], v[74:75], v[90:91]
    v_pk_add_f32 v[76:77], v[76:77], v[92:93]
    v_pk_add_f32 v[78:79], v[78:79], v[94:95]
    v_pk_add_f32 v[80:81], v[80:81], v[96:97]
    v_pk_add_f32 v[82:83], v[82:83], v[98:99]
    v_pk_add_f32 v[84:85], v[84:85], v[116:117]
    v_pk_add_f32 v[86:87], v[86:87], v[118:119]
    s_waitcnt lgkmcnt(10)
    v_pk_add_f32 v[72:73], v[72:73], v[144:145]
    v_pk_add_f32 v[74:75], v[74:75], v[146:147]
    v_pk_add_f32 v[76:77], v[76:77], v[148:149]
    v_pk_add_f32 v[78:79], v[78:79], v[150:151]
    s_waitcnt lgkmcnt(8)
    v_pk_add_f32 v[72:73], v[72:73], v[160:161]
    v_pk_add_f32 v[74:75], v[74:75], v[162:163]
    v_pk_add_f32 v[76:77], v[76:77], v[164:165]
    v_pk_add_f32 v[78:79], v[78:79], v[166:167]
    s_waitcnt lgkmcnt(6)
    v_pk_add_f32 v[72:73], v[72:73], v[176:177]
    v_pk_add_f32 v[74:75], v[74:75], v[178:179]
    v_pk_add_f32 v[76:77], v[76:77], v[180:181]
    v_pk_add_f32 v[78:79], v[78:79], v[182:183]
    v_cvt_pk_bf16_f32 v32, v72, v73
    v_cvt_pk_bf16_f32 v33, v74, v75
    v_cvt_pk_bf16_f32 v34, v76, v77
    v_cvt_pk_bf16_f32 v35, v78, v79
    s_nop 0
    v_permlane32_swap_b32 v32, v34
    v_permlane32_swap_b32 v33, v35
    buffer_store_dwordx4 v[32:35], v5, s[36:39], 0 offen offset:0
    s_waitcnt lgkmcnt(4)
    v_pk_add_f32 v[80:81], v[80:81], v[152:153]
    v_pk_add_f32 v[82:83], v[82:83], v[154:155]
    v_pk_add_f32 v[84:85], v[84:85], v[156:157]
    v_pk_add_f32 v[86:87], v[86:87], v[158:159]
    s_waitcnt lgkmcnt(2)
    v_pk_add_f32 v[80:81], v[80:81], v[168:169]
    v_pk_add_f32 v[82:83], v[82:83], v[170:171]
    v_pk_add_f32 v[84:85], v[84:85], v[172:173]
    v_pk_add_f32 v[86:87], v[86:87], v[174:175]
    s_waitcnt lgkmcnt(0)
    v_pk_add_f32 v[80:81], v[80:81], v[184:185]
    v_pk_add_f32 v[82:83], v[82:83], v[186:187]
    v_pk_add_f32 v[84:85], v[84:85], v[188:189]
    v_pk_add_f32 v[86:87], v[86:87], v[190:191]
    v_cvt_pk_bf16_f32 v36, v80, v81
    v_cvt_pk_bf16_f32 v37, v82, v83
    v_cvt_pk_bf16_f32 v38, v84, v85
    v_cvt_pk_bf16_f32 v39, v86, v87
    s_nop 0
    v_permlane32_swap_b32 v36, v38
    v_permlane32_swap_b32 v37, v39
    buffer_store_dwordx4 v[36:39], v5, s[36:39], 0 offen offset:32
L_end:
    s_endpgm
L_slown:
    s_mov_b32 s99, 40000
    v_mov_b32 v66, 0
L_slownl:
    buffer_load_dword v9, v66, s[36:39], 0 offen sc1
    s_waitcnt vmcnt(0)
    v_readfirstlane_b32 s31, v9
    s_nop 1
    s_cmp_lg_u32 s31, 0
    s_cbranch_scc1 L_backn
    s_sub_u32 s99, s99, 1
    s_cmp_lg_u32 s99, 0
    s_cbranch_scc1 L_slownl
    s_branch L_backn
L_slow0:
    s_mov_b32 s99, 40000
L_slowl0:
    buffer_load_dword v9, v10, s[32:35], 0 offen sc1
    s_waitcnt vmcnt(0)
    v_and_b32 v9, -16, v9
    v_cmp_ne_u32 vcc, s31, v9
    s_nop 1
    s_cbranch_vccz L_back0
    s_sub_u32 s99, s99, 1
    s_cmp_lg_u32 s99, 0
    s_cbranch_scc1 L_slowl0
    s_branch L_back0
L_pois:
    s_mov_b32 s55, 4325376
    buffer_store_dwordx4 v[240:243], v4, s[32:35], s70 offen offset:0 sc1
    buffer_store_dwordx4 v[240:243], v4, s[32:35], s70 offen offset:1024 sc1
    buffer_store_dwordx4 v[240:243], v4, s[32:35], s97 offen offset:0 sc1
    buffer_store_dwordx4 v[240:243], v4, s[32:35], s97 offen offset:1024 sc1
    buffer_store_dwordx4 v[240:243], v4, s[32:35], s97 offen offset:2048 sc1
    buffer_store_dwordx4 v[240:243], v4, s[32:35], s97 offen offset:3072 sc1
    buffer_store_dwordx4 v[240:243], v0, s[32:35], s97 offen offset:0 sc1
    buffer_store_dwordx4 v[240:243], v0, s[32:35], s97 offen offset:1024 sc1
    buffer_store_dwordx4 v[240:243], v0, s[32:35], s97 offen offset:2048 sc1
    buffer_store_dwordx4 v[240:243], v216, s[32:35], s55 offen offset:0 sc1
    buffer_store_dwordx4 v[240:243], v217, s[32:35], s55 offen offset:2048 sc1
    s_waitcnt vmcnt(0)
    s_mov_b32 s55, s101
    s_branch L_poisb
L_slow2:
    s_mov_b32 s99, 40000
L_slowl2:
    buffer_load_dword v9, v213, s[32:35], 0 offen sc1
    s_waitcnt vmcnt(0)
        v_cmp_ne_u32 vcc, s31, v9
    s_nop 1
    s_cbranch_vccz L_back2
    s_sub_u32 s99, s99, 1
    s_cmp_lg_u32 s99, 0
    s_cbranch_scc1 L_slowl2
    s_branch L_back2
L_slow3:
    s_mov_b32 s99, 40000
L_slowl3:
    buffer_load_dword v9, v218, s[32:35], 0 offen sc1
    s_waitcnt vmcnt(0)
        v_cmp_ne_u32 vcc, s31, v9
    s_nop 1
    s_cbranch_vccz L_back3
    s_sub_u32 s99, s99, 1
    s_cmp_lg_u32 s99, 0
    s_cbranch_scc1 L_slowl3
    s_branch L_back3
L_slow4:
    s_mov_b32 s99, 40000
L_slowl4:
    buffer_load_dword v9, v10, s[32:35], 0 offen sc1
    s_waitcnt vmcnt(0)
        v_cmp_ne_u32 vcc, s31, v9
    s_nop 1
    s_cbranch_vccz L_back4
    s_sub_u32 s99, s99, 1
    s_cmp_lg_u32 s99, 0
    s_cbranch_scc1 L_slowl4
    s_branch L_back4
L_fb:
    s_waitcnt vmcnt(0) lgkmcnt(0)
    s_mov_b32 s74, -1
    s_and_b32 s53, s78, 0xffff0fff
    s_mov_b32 exec_lo, 0
    v_mov_b32 v54, 0
    v_mov_b32 v55, 0
    v_mov_b32 v62, 0
    v_mov_b32 v63, 0
    v_mov_b32 v70, 0
    v_mov_b32 v71, 0
    v_mov_b32 v78, 0
    v_mov_b32 v79, 0
    s_mov_b32 exec_lo, -1
    v_mov_b32 v32, 0xff800000
    v_mov_b32 v33, 0xff800000
    v_mov_b32 v34, 0xff800000
    v_mov_b32 v35, 0xff800000
    s_mov_b32 s52, s53
    s_mov_b32 s54, 16
    s_barrier
L_fb1:
    buffer_load_dwordx4 v[112:115], v4, s[32:35], s52 offen offset:0 sc1
    buffer_load_dwordx4 v[116:119], v4, s[32:35], s52 offen offset:1024 sc1
    s_waitcnt vmcnt(0)
    v_mfma_f32_32x32x16_bf16 v[16:31], v[112:115], v[48:51], 0
    v_mfma_f32_32x32x16_bf16 v[16:31], v[116:119], v[52:55], v[16:31]
    s_nop 7
    s_nop 3
    v_max3_f32 v32, v32, v16, v17
    v_max3_f32 v32, v32, v18, v19
    v_max3_f32 v32, v32, v20, v21
    v_max3_f32 v32, v32, v22, v23
    v_max3_f32 v32, v32, v24, v25
    v_max3_f32 v32, v32, v26, v27
    v_max3_f32 v32, v32, v28, v29
    v_max3_f32 v32, v32, v30, v31
    v_mfma_f32_32x32x16_bf16 v[16:31], v[112:115], v[56:59], 0
    v_mfma_f32_32x32x16_bf16 v[16:31], v[116:119], v[60:63], v[16:31]
    s_nop 7
    s_nop 3
    v_max3_f32 v33, v33, v16, v17
    v_max3_f32 v33, v33, v18, v19
    v_max3_f32 v33, v33, v20, v21
    v_max3_f32 v33, v33, v22, v23
    v_max3_f32 v33, v33, v24, v25
    v_max3_f32 v33, v33, v26, v27
    v_max3_f32 v33, v33, v28, v29
    v_max3_f32 v33, v33, v30, v31
    v_mfma_f32_32x32x16_bf16 v[16:31], v[112:115], v[64:67], 0
    v_mfma_f32_32x32x16_bf16 v[16:31], v[116:119], v[68:71], v[16:31]
    s_nop 7
    s_nop 3
    v_max3_f32 v34, v34, v16, v17
    v_max3_f32 v34, v34, v18, v19
    v_max3_f32 v34, v34, v20, v21
    v_max3_f32 v34, v34, v22, v23
    v_max3_f32 v34, v34, v24, v25
    v_max3_f32 v34, v34, v26, v27
    v_max3_f32 v34, v34, v28, v29
    v_max3_f32 v34, v34, v30, v31
    v_mfma_f32_32x32x16_bf16 v[16:31], v[112:115], v[72:75], 0
    v_mfma_f32_32x32x16_bf16 v[16:31], v[116:119], v[76:79], v[16:31]
    s_nop 7
    s_nop 3
    v_max3_f32 v35, v35, v16, v17
    v_max3_f32 v35, v35, v18, v19
    v_max3_f32 v35, v35, v20, v21
    v_max3_f32 v35, v35, v22, v23
    v_max3_f32 v35, v35, v24, v25
    v_max3_f32 v35, v35, v26, v27
    v_max3_f32 v35, v35, v28, v29
    v_max3_f32 v35, v35, v30, v31
    s_add_u32 s52, s52, 4096
    s_sub_u32 s54, s54, 1
    s_cmp_lg_u32 s54, 0
    s_nop 7
    s_cbranch_scc1 L_fb1
    v_and_b32 v36, 31, v1
    v_lshlrev_b32 v36, 2, v36
    s_lshl_b32 s55, s30, 9
    v_mov_b32 v37, v32
    s_nop 1
    v_permlane32_swap_b32 v32, v37
    v_max_f32 v32, v32, v37
    s_add_u32 s52, s30, 1
    s_and_b32 s52, s52, 3
    s_lshl_b32 s52, s52, 7
    s_add_u32 s52, s52, 8192
    v_add_u32 v40, s52, v36
    v_add_u32 v38, s55, v40
    ds_write_b32 v38, v32
    v_mov_b32 v37, v33
    s_nop 1
    v_permlane32_swap_b32 v33, v37
    v_max_f32 v33, v33, v37
    s_add_u32 s52, s30, 2
    s_and_b32 s52, s52, 3
    s_lshl_b32 s52, s52, 7
    s_add_u32 s52, s52, 8192
    v_add_u32 v41, s52, v36
    v_add_u32 v38, s55, v41
    ds_write_b32 v38, v33
    v_mov_b32 v37, v34
    s_nop 1
    v_permlane32_swap_b32 v34, v37
    v_max_f32 v34, v34, v37
    s_add_u32 s52, s30, 3
    s_and_b32 s52, s52, 3
    s_lshl_b32 s52, s52, 7
    s_add_u32 s52, s52, 8192
    v_add_u32 v42, s52, v36
    v_add_u32 v38, s55, v42
    ds_write_b32 v38, v34
    v_mov_b32 v37, v35
    s_nop 1
    v_permlane32_swap_b32 v35, v37
    v_max_f32 v35, v35, v37
    s_add_u32 s52, s30, 4
    s_and_b32 s52, s52, 3
    s_lshl_b32 s52, s52, 7
    s_add_u32 s52, s52, 8192
    v_add_u32 v43, s52, v36
    v_add_u32 v38, s55, v43
    ds_write_b32 v38, v35
    s_waitcnt lgkmcnt(0)
    s_barrier
    ds_read_b32 v16, v40 offset:0
    ds_read_b32 v17, v40 offset:512
    ds_read_b32 v18, v40 offset:1024
    ds_read_b32 v19, v40 offset:1536
    ds_read_b32 v20, v41 offset:0
    ds_read_b32 v21, v41 offset:512
    ds_read_b32 v22, v41 offset:1024
    ds_read_b32 v23, v41 offset:1536
    ds_read_b32 v24, v42 offset:0
    ds_read_b32 v25, v42 offset:512
    ds_read_b32 v26, v42 offset:1024
    ds_read_b32 v27, v42 offset:1536
    ds_read_b32 v28, v43 offset:0
    ds_read_b32 v29, v43 offset:512
    ds_read_b32 v30, v43 offset:1024
    ds_read_b32 v31, v43 offset:1536
    s_waitcnt lgkmcnt(0)
    v_max3_f32 v16, v16, v17, v18
    v_max_f32 v16, v16, v19
    v_cvt_pk_bf16_f32 v17, -v16, -v16
    v_lshlrev_b32 v17, 16, v17
    v_sub_f32 v16, -v16, v17
    v_cvt_pk_bf16_f32 v18, v16, v16
    v_lshlrev_b32 v18, 16, v18
    v_sub_f32 v16, v16, v18
    s_mov_b32 exec_lo, 0
    v_cvt_pk_bf16_f32 v54, v17, v18
    v_cvt_pk_bf16_f32 v55, v16, 0
    s_mov_b32 exec_lo, -1
    v_max3_f32 v20, v20, v21, v22
    v_max_f32 v20, v20, v23
    v_cvt_pk_bf16_f32 v21, -v20, -v20
    v_lshlrev_b32 v21, 16, v21
    v_sub_f32 v20, -v20, v21
    v_cvt_pk_bf16_f32 v22, v20, v20
    v_lshlrev_b32 v22, 16, v22
    v_sub_f32 v20, v20, v22
    s_mov_b32 exec_lo, 0
    v_cvt_pk_bf16_f32 v62, v21, v22
    v_cvt_pk_bf16_f32 v63, v20, 0
    s_mov_b32 exec_lo, -1
    v_max3_f32 v24, v24, v25, v26
    v_max_f32 v24, v24, v27
    v_cvt_pk_bf16_f32 v25, -v24, -v24
    v_lshlrev_b32 v25, 16, v25
    v_sub_f32 v24, -v24, v25
    v_cvt_pk_bf16_f32 v26, v24, v24
    v_lshlrev_b32 v26, 16, v26
    v_sub_f32 v24, v24, v26
    s_mov_b32 exec_lo, 0
    v_cvt_pk_bf16_f32 v70, v25, v26
    v_cvt_pk_bf16_f32 v71, v24, 0
    s_mov_b32 exec_lo, -1
    v_max3_f32 v28, v28, v29, v30
    v_max_f32 v28, v28, v31
    v_cvt_pk_bf16_f32 v29, -v28, -v28
    v_lshlrev_b32 v29, 16, v29
    v_sub_f32 v28, -v28, v29
    v_cvt_pk_bf16_f32 v30, v28, v28
    v_lshlrev_b32 v30, 16, v30
    v_sub_f32 v28, v28, v30
    s_mov_b32 exec_lo, 0
    v_cvt_pk_bf16_f32 v78, v29, v30
    v_cvt_pk_bf16_f32 v79, v28, 0
    s_mov_b32 exec_lo, -1
    v_accvgpr_write_b32 a208, 0
    v_accvgpr_write_b32 a209, 0
    v_accvgpr_write_b32 a210, 0
    v_accvgpr_write_b32 a211, 0
    v_accvgpr_write_b32 a212, 0
    v_accvgpr_write_b32 a213, 0
    v_accvgpr_write_b32 a214, 0
    v_accvgpr_write_b32 a215, 0
    v_accvgpr_write_b32 a216, 0
    v_accvgpr_write_b32 a217, 0
    v_accvgpr_write_b32 a218, 0
    v_accvgpr_write_b32 a219, 0
    v_accvgpr_write_b32 a220, 0
    v_accvgpr_write_b32 a221, 0
    v_accvgpr_write_b32 a222, 0
    v_accvgpr_write_b32 a223, 0
    v_accvgpr_write_b32 a224, 0
    v_accvgpr_write_b32 a225, 0
    v_accvgpr_write_b32 a226, 0
    v_accvgpr_write_b32 a227, 0
    v_accvgpr_write_b32 a228, 0
    v_accvgpr_write_b32 a229, 0
    v_accvgpr_write_b32 a230, 0
    v_accvgpr_write_b32 a231, 0
    v_accvgpr_write_b32 a232, 0
    v_accvgpr_write_b32 a233, 0
    v_accvgpr_write_b32 a234, 0
    v_accvgpr_write_b32 a235, 0
    v_accvgpr_write_b32 a236, 0
    v_accvgpr_write_b32 a237, 0
    v_accvgpr_write_b32 a238, 0
    v_accvgpr_write_b32 a239, 0
    v_accvgpr_write_b32 a240, 0
    v_accvgpr_write_b32 a241, 0
    v_accvgpr_write_b32 a242, 0
    v_accvgpr_write_b32 a243, 0
    v_accvgpr_write_b32 a244, 0
    v_accvgpr_write_b32 a245, 0
    v_accvgpr_write_b32 a246, 0
    v_accvgpr_write_b32 a247, 0
    v_accvgpr_write_b32 a248, 0
    v_accvgpr_write_b32 a249, 0
    v_accvgpr_write_b32 a250, 0
    v_accvgpr_write_b32 a251, 0
    v_accvgpr_write_b32 a252, 0
    v_accvgpr_write_b32 a253, 0
    v_accvgpr_write_b32 a254, 0
    v_accvgpr_write_b32 a255, 0
    v_mov_b32 v128, 0
    v_mov_b32 v129, 0
    v_mov_b32 v130, 0
    v_mov_b32 v131, 0
    v_mov_b32 v132, 0
    v_mov_b32 v133, 0
    v_mov_b32 v134, 0
    v_mov_b32 v135, 0
    v_mov_b32 v136, 0
    v_mov_b32 v137, 0
    v_mov_b32 v138, 0
    v_mov_b32 v139, 0
    v_mov_b32 v140, 0
    v_mov_b32 v141, 0
    v_mov_b32 v142, 0
    v_mov_b32 v143, 0
    s_mov_b32 s52, s53
    s_mov_b32 s54, 16
    s_barrier
L_fb2:
    buffer_load_dwordx4 v[112:115], v4, s[32:35], s52 offen offset:0 sc1
    buffer_load_dwordx4 v[116:119], v4, s[32:35], s52 offen offset:1024 sc1
    buffer_load_dwordx4 v[120:123], v4, s[32:35], s52 offen offset:2048 sc1
    buffer_load_dwordx4 v[124:127], v4, s[32:35], s52 offen offset:3072 sc1
    s_waitcnt vmcnt(0)
    v_mfma_f32_32x32x16_bf16 v[16:31], v[112:115], v[48:51], 0
    v_mfma_f32_32x32x16_bf16 v[16:31], v[116:119], v[52:55], v[16:31]
    s_nop 7
    s_nop 3
    v_exp_f32 v16, v16
    v_exp_f32 v17, v17
    v_exp_f32 v18, v18
    v_exp_f32 v19, v19
    v_exp_f32 v20, v20
    v_exp_f32 v21, v21
    v_exp_f32 v22, v22
    v_exp_f32 v23, v23
    v_exp_f32 v24, v24
    v_exp_f32 v25, v25
    v_exp_f32 v26, v26
    v_exp_f32 v27, v27
    v_exp_f32 v28, v28
    v_exp_f32 v29, v29
    v_exp_f32 v30, v30
    v_exp_f32 v31, v31
    v_perm_b32 v16, v17, v16, s3
    v_perm_b32 v17, v19, v18, s3
    v_perm_b32 v18, v21, v20, s3
    v_perm_b32 v19, v23, v22, s3
    v_perm_b32 v20, v25, v24, s3
    v_perm_b32 v21, v27, v26, s3
    v_perm_b32 v22, v29, v28, s3
    v_perm_b32 v23, v31, v30, s3
    v_mfma_f32_32x32x16_bf16 a[208:223], v[120:123], v[16:19], a[208:223]
    s_nop 0
    v_mfma_f32_32x32x16_bf16 a[208:223], v[124:127], v[20:23], a[208:223]
    v_mfma_f32_32x32x16_bf16 v[16:31], v[112:115], v[56:59], 0
    v_mfma_f32_32x32x16_bf16 v[16:31], v[116:119], v[60:63], v[16:31]
    s_nop 7
    s_nop 3
    v_exp_f32 v16, v16
    v_exp_f32 v17, v17
    v_exp_f32 v18, v18
    v_exp_f32 v19, v19
    v_exp_f32 v20, v20
    v_exp_f32 v21, v21
    v_exp_f32 v22, v22
    v_exp_f32 v23, v23
    v_exp_f32 v24, v24
    v_exp_f32 v25, v25
    v_exp_f32 v26, v26
    v_exp_f32 v27, v27
    v_exp_f32 v28, v28
    v_exp_f32 v29, v29
    v_exp_f32 v30, v30
    v_exp_f32 v31, v31
    v_perm_b32 v16, v17, v16, s3
    v_perm_b32 v17, v19, v18, s3
    v_perm_b32 v18, v21, v20, s3
    v_perm_b32 v19, v23, v22, s3
    v_perm_b32 v20, v25, v24, s3
    v_perm_b32 v21, v27, v26, s3
    v_perm_b32 v22, v29, v28, s3
    v_perm_b32 v23, v31, v30, s3
    v_mfma_f32_32x32x16_bf16 a[224:239], v[120:123], v[16:19], a[224:239]
    s_nop 0
    v_mfma_f32_32x32x16_bf16 a[224:239], v[124:127], v[20:23], a[224:239]
    v_mfma_f32_32x32x16_bf16 v[16:31], v[112:115], v[64:67], 0
    v_mfma_f32_32x32x16_bf16 v[16:31], v[116:119], v[68:71], v[16:31]
    s_nop 7
    s_nop 3
    v_exp_f32 v16, v16
    v_exp_f32 v17, v17
    v_exp_f32 v18, v18
    v_exp_f32 v19, v19
    v_exp_f32 v20, v20
    v_exp_f32 v21, v21
    v_exp_f32 v22, v22
    v_exp_f32 v23, v23
    v_exp_f32 v24, v24
    v_exp_f32 v25, v25
    v_exp_f32 v26, v26
    v_exp_f32 v27, v27
    v_exp_f32 v28, v28
    v_exp_f32 v29, v29
    v_exp_f32 v30, v30
    v_exp_f32 v31, v31
    v_perm_b32 v16, v17, v16, s3
    v_perm_b32 v17, v19, v18, s3
    v_perm_b32 v18, v21, v20, s3
    v_perm_b32 v19, v23, v22, s3
    v_perm_b32 v20, v25, v24, s3
    v_perm_b32 v21, v27, v26, s3
    v_perm_b32 v22, v29, v28, s3
    v_perm_b32 v23, v31, v30, s3
    v_mfma_f32_32x32x16_bf16 a[240:255], v[120:123], v[16:19], a[240:255]
    s_nop 0
    v_mfma_f32_32x32x16_bf16 a[240:255], v[124:127], v[20:23], a[240:255]
    v_mfma_f32_32x32x16_bf16 v[16:31], v[112:115], v[72:75], 0
    v_mfma_f32_32x32x16_bf16 v[16:31], v[116:119], v[76:79], v[16:31]
    s_nop 7
    s_nop 3
    v_exp_f32 v16, v16
    v_exp_f32 v17, v17
    v_exp_f32 v18, v18
    v_exp_f32 v19, v19
    v_exp_f32 v20, v20
    v_exp_f32 v21, v21
    v_exp_f32 v22, v22
    v_exp_f32 v23, v23
    v_exp_f32 v24, v24
    v_exp_f32 v25, v25
    v_exp_f32 v26, v26
    v_exp_f32 v27, v27
    v_exp_f32 v28, v28
    v_exp_f32 v29, v29
    v_exp_f32 v30, v30
    v_exp_f32 v31, v31
    v_perm_b32 v16, v17, v16, s3
    v_perm_b32 v17, v19, v18, s3
    v_perm_b32 v18, v21, v20, s3
    v_perm_b32 v19, v23, v22, s3
    v_perm_b32 v20, v25, v24, s3
    v_perm_b32 v21, v27, v26, s3
    v_perm_b32 v22, v29, v28, s3
    v_perm_b32 v23, v31, v30, s3
    v_mfma_f32_32x32x16_bf16 v[128:143], v[120:123], v[16:19], v[128:143]
    s_nop 0
    v_mfma_f32_32x32x16_bf16 v[128:143], v[124:127], v[20:23], v[128:143]
    s_add_u32 s52, s52, 4096
    s_sub_u32 s54, s54, 1
    s_cmp_lg_u32 s54, 0
    s_nop 7
    s_cbranch_scc1 L_fb2
    s_nop 7
    ds_write_b128 v220, a[208:211] offset:0
    ds_write_b128 v220, a[212:215] offset:1024
    ds_write_b128 v220, a[216:219] offset:2048
    ds_write_b128 v220, a[220:223] offset:3072
    ds_write_b128 v221, a[224:227] offset:4096
    ds_write_b128 v221, a[228:231] offset:5120
    ds_write_b128 v221, a[232:235] offset:6144
    ds_write_b128 v221, a[236:239] offset:7168
    ds_write_b128 v222, a[240:243] offset:8192
    ds_write_b128 v222, a[244:247] offset:9216
    ds_write_b128 v222, a[248:251] offset:10240
    ds_write_b128 v222, a[252:255] offset:11264
    s_branch L_comb
L_slow6:
    s_waitcnt vmcnt(0)
    buffer_store_dwordx4 v[114:117], v4, s[32:35], s70 offen offset:0 sc1
    buffer_store_dwordx4 v[118:121], v4, s[32:35], s70 offen offset:1024 sc1
    s_waitcnt vmcnt(0)
    s_branch L_back6
L_slow7:
    s_mov_b32 s99, 40000
L_slowl7:
    buffer_load_dwordx4 v[144:147], v209, s[32:35], 0 offen offset:0 sc1
    buffer_load_dwordx4 v[148:151], v209, s[32:35], 0 offen offset:1024 sc1
    s_waitcnt vmcnt(0)
    v_max3_u32 v9, v144, v148, v144
    v_cmp_eq_u32 vcc, -1, v9
    s_nop 1
    s_cbranch_vccz L_back7
    s_sub_u32 s99, s99, 1
    s_cmp_lg_u32 s99, 0
    s_cbranch_scc1 L_slowl7
    s_branch L_back7
L_slow8:
    s_waitcnt vmcnt(0)
    buffer_store_dwordx4 v[32:35], v216, s[32:35], s65 offen offset:0 sc1
    buffer_store_dwordx4 v[36:39], v217, s[32:35], s65 offen offset:2048 sc1
    buffer_store_dwordx2 v[24:25], v30, s[32:35], s61 offen sc1
    s_waitcnt vmcnt(0)
    s_branch L_back8
L_slow9:
    s_mov_b32 s99, 40000
L_slowl9:
    buffer_load_dwordx4 v[144:147], v4, s[32:35], s78 offen sc1
    buffer_load_dwordx4 v[148:151], v132, s[32:35], s78 offen sc1
    buffer_load_dwordx4 v[152:155], v4, s[32:35], s79 offen sc1
    buffer_load_dwordx4 v[156:159], v132, s[32:35], s79 offen sc1
    s_waitcnt vmcnt(0)
    v_max3_u32 v9, v144, v148, v152
    v_max3_u32 v9, v9, v156, v156
    v_cmp_eq_u32 vcc, -1, v9
    s_nop 1
    s_cbranch_vccz L_back9
    s_sub_u32 s99, s99, 1
    s_cmp_lg_u32 s99, 0
    s_cbranch_scc1 L_slowl9
    s_branch L_back9
L_slow10:
    s_mov_b32 s99, 40000
L_slowl10:
    buffer_load_dwordx4 v[160:163], v4, s[32:35], s80 offen sc1
    buffer_load_dwordx4 v[164:167], v132, s[32:35], s80 offen sc1
    buffer_load_dwordx4 v[168:171], v4, s[32:35], s81 offen sc1
    buffer_load_dwordx4 v[172:175], v132, s[32:35], s81 offen sc1
    buffer_load_dwordx4 v[176:179], v4, s[32:35], s82 offen sc1
    buffer_load_dwordx4 v[180:183], v132, s[32:35], s82 offen sc1
    s_waitcnt vmcnt(0)
    v_max3_u32 v9, v160, v164, v168
    v_max3_u32 v9, v9, v172, v176
    v_max3_u32 v9, v9, v180, v180
    v_cmp_eq_u32 vcc, -1, v9
    s_nop 1
    s_cbranch_vccz L_back10
    s_sub_u32 s99, s99, 1
    s_cmp_lg_u32 s99, 0
    s_cbranch_scc1 L_slowl10
    s_branch L_back10
L_slow11:
    s_mov_b32 s99, 40000
L_slowl11:
    buffer_load_dwordx4 v[184:187], v4, s[32:35], s83 offen sc1
    buffer_load_dwordx4 v[188:191], v132, s[32:35], s83 offen sc1
    buffer_load_dwordx4 v[192:195], v4, s[32:35], s84 offen sc1
    buffer_load_dwordx4 v[196:199], v132, s[32:35], s84 offen sc1
    buffer_load_dwordx4 v[200:203], v4, s[32:35], s85 offen sc1
    buffer_load_dwordx4 v[204:207], v132, s[32:35], s85 offen sc1
    buffer_load_dwordx4 v[208:211], v4, s[32:35], s86 offen sc1
    buffer_load_dwordx4 v[212:215], v132, s[32:35], s86 offen sc1
    s_waitcnt vmcnt(0)
    v_max3_u32 v9, v184, v188, v192
    v_max3_u32 v9, v9, v196, v200
    v_max3_u32 v9, v9, v204, v208
    v_max3_u32 v9, v9, v212, v212
    v_cmp_eq_u32 vcc, -1, v9
    s_nop 1
    s_cbranch_vccz L_back11
    s_sub_u32 s99, s99, 1
    s_cmp_lg_u32 s99, 0
    s_cbranch_scc1 L_slowl11
    s_branch L_back11
L_slow12:
    s_mov_b32 s99, 40000
L_slowl12:
    buffer_load_dwordx4 v[216:219], v4, s[32:35], s87 offen sc1
    buffer_load_dwordx4 v[220:223], v132, s[32:35], s87 offen sc1
    buffer_load_dwordx4 v[224:227], v4, s[32:35], s88 offen sc1
    buffer_load_dwordx4 v[228:231], v132, s[32:35], s88 offen sc1
    buffer_load_dwordx4 v[232:235], v4, s[32:35], s89 offen sc1
    buffer_load_dwordx4 v[236:239], v132, s[32:35], s89 offen sc1
    buffer_load_dwordx4 v[240:243], v4, s[32:35], s90 offen sc1
    buffer_load_dwordx4 v[244:247], v132, s[32:35], s90 offen sc1
    buffer_load_dwordx4 v[248:251], v4, s[32:35], s91 offen sc1
    buffer_load_dwordx4 v[252:255], v132, s[32:35], s91 offen sc1
    s_waitcnt vmcnt(0)
    v_max3_u32 v9, v216, v220, v224
    v_max3_u32 v9, v9, v228, v232
    v_max3_u32 v9, v9, v236, v240
    v_max3_u32 v9, v9, v244, v248
    v_max3_u32 v9, v9, v252, v252
    v_cmp_eq_u32 vcc, -1, v9
    s_nop 1
    s_cbranch_vccz L_back12
    s_sub_u32 s99, s99, 1
    s_cmp_lg_u32 s99, 0
    s_cbranch_scc1 L_slowl12
    s_branch L_back12
L_slow13:
    s_waitcnt vmcnt(0)
    buffer_store_dwordx4 v[44:47], v128, s[32:35], s97 offen offset:0 sc1
    buffer_store_dwordx4 v[48:51], v128, s[32:35], s97 offen offset:1024 sc1
    buffer_store_dwordx4 v[52:55], v128, s[32:35], s97 offen offset:2048 sc1
    buffer_store_dwordx4 v[56:59], v128, s[32:35], s97 offen offset:3072 sc1
    buffer_store_dwordx4 v[60:63], v129, s[32:35], s97 offen offset:0 sc1
    s_waitcnt vmcnt(0)
    s_branch L_back13
L_slow14:
    s_mov_b32 s99, 40000
L_slowl14:
    buffer_load_dwordx4 v[144:147], v142, s[32:35], s66 offen offset:0 sc1
    buffer_load_dwordx4 v[148:151], v143, s[32:35], s66 offen offset:0 sc1
    buffer_load_dwordx4 v[152:155], v142, s[32:35], s67 offen offset:0 sc1
    buffer_load_dwordx4 v[156:159], v143, s[32:35], s67 offen offset:0 sc1
    buffer_load_dwordx4 v[160:163], v142, s[32:35], s68 offen offset:0 sc1
    buffer_load_dwordx4 v[164:167], v143, s[32:35], s68 offen offset:0 sc1
    buffer_load_dwordx4 v[168:171], v142, s[32:35], s69 offen offset:0 sc1
    buffer_load_dwordx4 v[172:175], v143, s[32:35], s69 offen offset:0 sc1
    s_waitcnt vmcnt(0)
    v_max3_u32 v9, v144, v148, v152
    v_max3_u32 v9, v9, v156, v160
    v_max3_u32 v9, v9, v164, v168
    v_max3_u32 v9, v9, v172, v172
    v_cmp_eq_u32 vcc, -1, v9
    s_nop 1
    s_cbranch_vccz L_back14
    s_sub_u32 s99, s99, 1
    s_cmp_lg_u32 s99, 0
    s_cbranch_scc1 L_slowl14
    s_branch L_back14
L_slow15:
    s_waitcnt vmcnt(0)
    buffer_store_dwordx4 v[64:67], v129, s[32:35], s97 offen offset:1024 sc1
    buffer_store_dwordx4 v[68:71], v129, s[32:35], s97 offen offset:2048 sc1
    s_waitcnt vmcnt(0)
    s_branch L_back15
L_slow16:
    s_mov_b32 s99, 40000
L_slowl16:
    buffer_load_dwordx4 v[176:179], v142, s[32:35], s66 offen offset:1024 sc1
    buffer_load_dwordx4 v[180:183], v143, s[32:35], s66 offen offset:1024 sc1
    buffer_load_dwordx4 v[184:187], v142, s[32:35], s67 offen offset:1024 sc1
    buffer_load_dwordx4 v[188:191], v143, s[32:35], s67 offen offset:1024 sc1
    buffer_load_dwordx4 v[192:195], v142, s[32:35], s68 offen offset:1024 sc1
    buffer_load_dwordx4 v[196:199], v143, s[32:35], s68 offen offset:1024 sc1
    buffer_load_dwordx4 v[200:203], v142, s[32:35], s69 offen offset:1024 sc1
    buffer_load_dwordx4 v[204:207], v143, s[32:35], s69 offen offset:1024 sc1
    s_waitcnt vmcnt(0)
    v_max3_u32 v9, v176, v180, v184
    v_max3_u32 v9, v9, v188, v192
    v_max3_u32 v9, v9, v196, v200
    v_max3_u32 v9, v9, v204, v204
    v_cmp_eq_u32 vcc, -1, v9
    s_nop 1
    s_cbranch_vccz L_back16
    s_sub_u32 s99, s99, 1
    s_cmp_lg_u32 s99, 0
    s_cbranch_scc1 L_slowl16
    s_branch L_back16
L_slow17:
    s_mov_b32 s99, 40000
L_slowl17:
    buffer_load_dwordx4 v[208:211], v142, s[32:35], s66 offen offset:2048 sc1
    buffer_load_dwordx4 v[212:215], v143, s[32:35], s66 offen offset:2048 sc1
    buffer_load_dwordx4 v[216:219], v142, s[32:35], s67 offen offset:2048 sc1
    buffer_load_dwordx4 v[220:223], v143, s[32:35], s67 offen offset:2048 sc1
    buffer_load_dwordx4 v[224:227], v142, s[32:35], s68 offen offset:2048 sc1
    buffer_load_dwordx4 v[228:231], v143, s[32:35], s68 offen offset:2048 sc1
    buffer_load_dwordx4 v[232:235], v142, s[32:35], s69 offen offset:2048 sc1
    buffer_load_dwordx4 v[236:239], v143, s[32:35], s69 offen offset:2048 sc1
    s_waitcnt vmcnt(0)
    v_max3_u32 v9, v208, v212, v216
    v_max3_u32 v9, v9, v220, v224
    v_max3_u32 v9, v9, v228, v232
    v_max3_u32 v9, v9, v236, v236
    v_cmp_eq_u32 vcc, -1, v9
    s_nop 1
    s_cbranch_vccz L_back17
    s_sub_u32 s99, s99, 1
    s_cmp_lg_u32 s99, 0
    s_cbranch_scc1 L_slowl17
    s_branch L_back17
L_slow18:
    s_mov_b32 s99, 40000
L_slowl18:
    buffer_load_dwordx4 v[120:123], v15, s[32:35], s73 offen offset:0 sc1
    buffer_load_dwordx4 v[124:127], v15, s[32:35], s73 offen offset:512 sc1
    buffer_load_dwordx2 v[138:139], v2, s[32:35], s62 offen sc1
    s_waitcnt vmcnt(0)
    v_max3_u32 v9, v120, v124, v139
    v_cmp_eq_u32 vcc, -1, v9
    s_nop 1
    s_cbranch_vccz L_back18
    s_sub_u32 s99, s99, 1
    s_cmp_lg_u32 s99, 0
    s_cbranch_scc1 L_slowl18
    s_branch L_back18
L_slow19:
    s_mov_b32 s99, 40000
L_slowl19:
    buffer_load_dwordx4 v[240:243], v142, s[32:35], s66 offen offset:3072 sc1
    buffer_load_dwordx4 v[244:247], v143, s[32:35], s66 offen offset:3072 sc1
    buffer_load_dwordx4 v[248:251], v142, s[32:35], s67 offen offset:3072 sc1
    buffer_load_dwordx4 v[252:255], v143, s[32:35], s67 offen offset:3072 sc1
    buffer_load_dwordx4 v[16:19], v142, s[32:35], s68 offen offset:3072 sc1
    buffer_load_dwordx4 v[20:23], v143, s[32:35], s68 offen offset:3072 sc1
    buffer_load_dwordx4 v[24:27], v142, s[32:35], s69 offen offset:3072 sc1
    buffer_load_dwordx4 v[28:31], v143, s[32:35], s69 offen offset:3072 sc1
    s_waitcnt vmcnt(0)
    v_max3_u32 v9, v240, v244, v248
    v_max3_u32 v9, v9, v252, v16
    v_max3_u32 v9, v9, v20, v24
    v_max3_u32 v9, v9, v28, v28
    v_cmp_eq_u32 vcc, -1, v9
    s_nop 1
    s_cbranch_vccz L_back19
    s_sub_u32 s99, s99, 1
    s_cmp_lg_u32 s99, 0
    s_cbranch_scc1 L_slowl19
    s_branch L_back19
L_slow20:
    s_mov_b32 s99, 40000
L_slowl20:
    buffer_load_dwordx4 v[32:35], v6, s[32:35], s66 offen offset:0 sc1
    buffer_load_dwordx4 v[36:39], v10, s[32:35], s66 offen offset:0 sc1
    buffer_load_dwordx4 v[40:43], v6, s[32:35], s67 offen offset:0 sc1
    buffer_load_dwordx4 v[44:47], v10, s[32:35], s67 offen offset:0 sc1
    buffer_load_dwordx4 v[48:51], v6, s[32:35], s68 offen offset:0 sc1
    buffer_load_dwordx4 v[52:55], v10, s[32:35], s68 offen offset:0 sc1
    buffer_load_dwordx4 v[56:59], v6, s[32:35], s69 offen offset:0 sc1
    buffer_load_dwordx4 v[60:63], v10, s[32:35], s69 offen offset:0 sc1
    s_waitcnt vmcnt(0)
    v_max3_u32 v9, v32, v36, v40
    v_max3_u32 v9, v9, v44, v48
    v_max3_u32 v9, v9, v52, v56
    v_max3_u32 v9, v9, v60, v60
    v_cmp_eq_u32 vcc, -1, v9
    s_nop 1
    s_cbranch_vccz L_back20
    s_sub_u32 s99, s99, 1
    s_cmp_lg_u32 s99, 0
    s_cbranch_scc1 L_slowl20
    s_branch L_back20
L_slow21:
    s_mov_b32 s99, 40000
L_slowl21:
    buffer_load_dwordx4 v[64:67], v6, s[32:35], s66 offen offset:1024 sc1
    buffer_load_dwordx4 v[68:71], v10, s[32:35], s66 offen offset:1024 sc1
    buffer_load_dwordx4 v[144:147], v6, s[32:35], s67 offen offset:1024 sc1
    buffer_load_dwordx4 v[148:151], v10, s[32:35], s67 offen offset:1024 sc1
    buffer_load_dwordx4 v[152:155], v6, s[32:35], s68 offen offset:1024 sc1
    buffer_load_dwordx4 v[156:159], v10, s[32:35], s68 offen offset:1024 sc1
    buffer_load_dwordx4 v[160:163], v6, s[32:35], s69 offen offset:1024 sc1
    buffer_load_dwordx4 v[164:167], v10, s[32:35], s69 offen offset:1024 sc1
    s_waitcnt vmcnt(0)
    v_max3_u32 v9, v64, v68, v144
    v_max3_u32 v9, v9, v148, v152
    v_max3_u32 v9, v9, v156, v160
    v_max3_u32 v9, v9, v164, v164
    v_cmp_eq_u32 vcc, -1, v9
    s_nop 1
    s_cbranch_vccz L_back21
    s_sub_u32 s99, s99, 1
    s_cmp_lg_u32 s99, 0
    s_cbranch_scc1 L_slowl21
    s_branch L_back21
L_slow22:
    s_mov_b32 s99, 40000
L_slowl22:
    buffer_load_dwordx4 v[168:171], v6, s[32:35], s66 offen offset:2048 sc1
    buffer_load_dwordx4 v[172:175], v10, s[32:35], s66 offen offset:2048 sc1
    buffer_load_dwordx4 v[176:179], v6, s[32:35], s67 offen offset:2048 sc1
    buffer_load_dwordx4 v[180:183], v10, s[32:35], s67 offen offset:2048 sc1
    buffer_load_dwordx4 v[184:187], v6, s[32:35], s68 offen offset:2048 sc1
    buffer_load_dwordx4 v[188:191], v10, s[32:35], s68 offen offset:2048 sc1
    buffer_load_dwordx4 v[192:195], v6, s[32:35], s69 offen offset:2048 sc1
    buffer_load_dwordx4 v[196:199], v10, s[32:35], s69 offen offset:2048 sc1
    s_waitcnt vmcnt(0)
    v_max3_u32 v9, v168, v172, v176
    v_max3_u32 v9, v9, v180, v184
    v_max3_u32 v9, v9, v188, v192
    v_max3_u32 v9, v9, v196, v196
    v_cmp_eq_u32 vcc, -1, v9
    s_nop 1
    s_cbranch_vccz L_back22
    s_sub_u32 s99, s99, 1
    s_cmp_lg_u32 s99, 0
    s_cbranch_scc1 L_slowl22
    s_branch L_back22
L_codeend:
    s_endpgm
.section .rodata,"a"
.p2align 6
.amdhsa_kernel sequential_preLN__grouped_kv_mqa__dense_activation_gelu__prompt_kernel
  .amdhsa_next_free_vgpr 512
  .amdhsa_next_free_sgpr 102
  .amdhsa_accum_offset 256
  .amdhsa_group_segment_fixed_size 0
  .amdhsa_kernarg_size 104
  .amdhsa_user_sgpr_count 2
  .amdhsa_user_sgpr_kernarg_segment_ptr 1
  .amdhsa_system_sgpr_workgroup_id_x 1
.end_amdhsa_kernel
```
